```python
import torch

def _softmax(x, axis=-1):
    return torch.softmax(x, dim=axis)
def _gelu(x):
    return torch.nn.functional.gelu(x, approximate="tanh")
def _silu(x):
    return torch.nn.functional.silu(x)
def _sigmoid(x):
    return torch.sigmoid(x)
def _layernorm(x, axis=-1, eps=1e-5):
    m = x.mean(dim=axis, keepdim=True)
    v = x.var(dim=axis, keepdim=True, unbiased=False)
    return (x - m) / torch.sqrt(v + eps)
def _scatter_add(tgt, idx, src, axis=0):
    return tgt.clone().index_add_(axis, idx, src)
def _segment_sum(src, seg, n):
    out = torch.zeros((n,) + src.shape[1:], dtype=src.dtype)
    return out.index_add_(0, seg, src)
def _pad(x, pw):
    flat = tuple(v for pair in reversed(pw) for v in pair)
    return torch.nn.functional.pad(x, flat)

kernel_name = 'parallel_sum__gqa_block_cached__swiglu_ffn__decode'

def setup_inputs():

    _w = (lambda a: (lambda t: t.to(torch.bfloat16) if t.is_floating_point() else t)(torch.as_tensor(a)))
    def _A_setup():
        B, Sq, D = 1, 1, 576
        Hq, Hkv, Sk, Dh = 32, 16, 16384, 128
        assert Hq % Hkv == 0, (Hq, Hkv)
        return {
            "x": _w((lambda *s: torch.randn(*s, dtype=torch.bfloat16) * 0.05)(B, Sq, D)),
            "k_cache": _w((lambda *s: torch.randn(*s, dtype=torch.bfloat16) * 3.2)(B, Hkv, Sk, Dh)),
            "v_cache": _w((lambda *s: torch.randn(*s, dtype=torch.bfloat16) * 1.6)(B, Hkv, Sk, Dh)),
            "wq": _w((lambda *s: torch.randn(*s, dtype=torch.bfloat16) * 3.2)(D, Hq * Dh) * (D ** -0.5)),
            "wo": _w((lambda *s: torch.randn(*s, dtype=torch.bfloat16) * 1.6)(Hq * Dh, D) * ((Hq * Dh) ** -0.5)),
        }
    _A_in = _A_setup()

    def _B_setup():
        B, S, D, F = 1, 1, 576, 4608
        return {
            "x": _w((lambda *s: torch.randn(*s, dtype=torch.bfloat16) * 0.05)(B, S, D)),
            "w_gate": _w((lambda *s: torch.randn(*s, dtype=torch.bfloat16) * 0.05)(D, F)),
            "w_up": _w((lambda *s: torch.randn(*s, dtype=torch.bfloat16) * 0.05)(D, F)),
            "w_down": _w((lambda *s: torch.randn(*s, dtype=torch.bfloat16) * 0.05)(F, D)),
        }
    _B_in = _B_setup()

    return {
        "A_x": _A_in["x"],
        "A_k_cache": _A_in["k_cache"],
        "A_v_cache": _A_in["v_cache"],
        "A_wq": _A_in["wq"],
        "A_wo": _A_in["wo"],
        "B_x": _B_in["x"],
        "B_w_gate": _B_in["w_gate"],
        "B_w_up": _B_in["w_up"],
        "B_w_down": _B_in["w_down"],
    }

def reference(A_x, A_k_cache, A_v_cache, A_wq, A_wo, B_x, B_w_gate, B_w_up, B_w_down):
    def _A_ref(x, k_cache, v_cache, wq, wo):
        B, Sq, D = x.shape
        Hq, Dh = 32, 128
        Hkv = k_cache.shape[1]
        rep = Hq // Hkv
        q = (lambda x, *d: x.permute(*d))((x @ wq).reshape(B, Sq, Hq, Dh), 0, 2, 1, 3)
        k = (lambda x, n, axis: torch.repeat_interleave(x, n, dim=axis))(k_cache, rep, axis=1)
        v = (lambda x, n, axis: torch.repeat_interleave(x, n, dim=axis))(v_cache, rep, axis=1)
        scores = torch.einsum("bhqd,bhkd->bhqk", q, k) * (Dh ** -0.5)
        p = _softmax(scores, axis=-1)
        o = torch.einsum("bhqk,bhkd->bhqd", p, v)
        return (lambda x, *d: x.permute(*d))(o, 0, 2, 1, 3).reshape(B, Sq, Hq * Dh) @ wo

    def _B_ref(x, w_gate, w_up, w_down):
        g = _silu(x @ w_gate)
        u = x @ w_up
        return (g * u) @ w_down

    x = A_x
    xn = _layernorm(x, axis=-1)
    return x + _A_ref(xn, A_k_cache, A_v_cache, A_wq, A_wo) + _B_ref(xn, B_w_gate, B_w_up, B_w_down)
```

```asm
; @launch grid=(256,1,1) block=(384,1,1) lds=8192
.amdgcn_target "amdgcn-amd-amdhsa--gfx950"
.text
.globl parallel_sum__gqa_block_cached__swiglu_ffn__decode_kernel
.p2align 8
.type parallel_sum__gqa_block_cached__swiglu_ffn__decode_kernel,@function
parallel_sum__gqa_block_cached__swiglu_ffn__decode_kernel:
  s_load_dwordx4 s[28:31], s[0:1], 48
  v_lshrrev_b32 v1, 6, v0
  s_cmp_ge_u32 s2, 256
  s_cbranch_scc1 L_end
  v_readfirstlane_b32 s3, v1
  v_and_b32 v0, 63, v0
  s_lshr_b32 s6, s2, 4
  v_lshrrev_b32 v15, 3, v0
  v_and_b32 v12, 7, v0
  s_cmp_ge_u32 s3, 4
  s_cbranch_scc1 L_P
  v_mul_u32_u24 v3, 9216, v15
  v_lshl_add_u32 v3, v12, 4, v3
  s_mul_i32 s97, s6, 331776
  s_and_b32 s15, s2, 7
  s_mul_i32 s15, s15, 1152
  s_add_u32 s97, s97, s15
  s_lshl_b32 s15, s3, 7
  s_add_u32 s97, s97, s15
  s_mov_b32 s50, 0x510000
  s_mov_b32 s51, 0x20000
  s_bitcmp1_b32 s2, 3
  s_waitcnt lgkmcnt(0)
  s_cselect_b32 s48, s30, s28
  s_cselect_b32 s49, s31, s29
  buffer_load_dwordx4 v[92:95], v3, s[48:51], s97 offen offset:0 nt
  buffer_load_dwordx4 v[96:99], v3, s[48:51], s97 offen offset:512 nt
  s_add_u32 s98, s97, 73728
  buffer_load_dwordx4 v[100:103], v3, s[48:51], s98 offen offset:0 nt
  buffer_load_dwordx4 v[104:107], v3, s[48:51], s98 offen offset:512 nt
  s_add_u32 s98, s97, 147456
  buffer_load_dwordx4 v[108:111], v3, s[48:51], s98 offen offset:0 nt
  buffer_load_dwordx4 v[112:115], v3, s[48:51], s98 offen offset:512 nt
  s_add_u32 s98, s97, 221184
  buffer_load_dwordx4 v[116:119], v3, s[48:51], s98 offen offset:0 nt
  buffer_load_dwordx4 v[120:123], v3, s[48:51], s98 offen offset:512 nt
  s_load_dwordx16 s[16:31], s[0:1], 0
  s_load_dwordx8 s[32:39], s[0:1], 64
  s_branch L_S1
L_P:
  s_load_dwordx16 s[16:31], s[0:1], 0
  s_load_dwordx8 s[32:39], s[0:1], 64
  s_cmp_eq_u32 s3, 5
  s_cbranch_scc1 L_C
  s_setprio 2
  v_mov_b32 v4, v15
  v_mov_b32 v5, v12
  v_lshlrev_b32 v1, 4, v0
  v_lshlrev_b32 v3, 1, v0
  v_mul_u32_u24 v2, 147456, v4
  v_lshl_add_u32 v2, v5, 4, v2
  s_mov_b32 s52, 0xba983210
  s_mov_b32 s53, 0xfedc7654
  s_lshl_b32 s54, s2, 2
  s_lshr_b64 s[52:53], s[52:53], s54
  s_and_b32 s54, s52, 15
  s_lshl_b32 s54, s54, 4
  s_add_u32 s54, s54, s6
  s_and_b32 s15, s6, 3
  s_mul_i32 s7, s15, 1179648
  s_lshr_b32 s14, s54, 2
  s_lshl_b32 s14, s14, 7
  s_add_u32 s7, s7, s14
  s_mov_b32 s42, 1152
  s_mov_b32 s43, 0x20000
  s_mov_b32 s46, 0x480000
  s_mov_b32 s47, 0x20000
  s_waitcnt lgkmcnt(0)
  s_mov_b32 s40, s16
  s_mov_b32 s41, s17
  s_mov_b32 s44, s22
  s_mov_b32 s45, s23
  s_load_dword s8, s[38:39], 0
  buffer_load_dwordx4 v[8:11], v1, s[40:43], 0 offen
  buffer_load_ushort v12, v3, s[40:43], 0 offen offset:1024
  buffer_load_dwordx4 v[64:67], v2, s[44:47], s7 offen nt
  s_addk_i32 s7, 8192
  buffer_load_dwordx4 v[68:71], v2, s[44:47], s7 offen nt
  s_addk_i32 s7, 8192
  buffer_load_dwordx4 v[72:75], v2, s[44:47], s7 offen nt
  s_addk_i32 s7, 8192
  buffer_load_dwordx4 v[76:79], v2, s[44:47], s7 offen nt
  s_addk_i32 s7, 8192
  buffer_load_dwordx4 v[80:83], v2, s[44:47], s7 offen nt
  s_addk_i32 s7, 8192
  buffer_load_dwordx4 v[84:87], v2, s[44:47], s7 offen nt
  s_addk_i32 s7, 8192
  buffer_load_dwordx4 v[88:91], v2, s[44:47], s7 offen nt
  s_addk_i32 s7, 8192
  buffer_load_dwordx4 v[92:95], v2, s[44:47], s7 offen nt
  s_addk_i32 s7, 8192
  buffer_load_dwordx4 v[96:99], v2, s[44:47], s7 offen nt
  s_addk_i32 s7, 8192
  buffer_load_dwordx4 v[100:103], v2, s[44:47], s7 offen nt
  s_addk_i32 s7, 8192
  buffer_load_dwordx4 v[104:107], v2, s[44:47], s7 offen nt
  s_addk_i32 s7, 8192
  buffer_load_dwordx4 v[108:111], v2, s[44:47], s7 offen nt
  s_addk_i32 s7, 8192
  buffer_load_dwordx4 v[112:115], v2, s[44:47], s7 offen nt
  s_addk_i32 s7, 8192
  buffer_load_dwordx4 v[116:119], v2, s[44:47], s7 offen nt
  s_addk_i32 s7, 8192
  buffer_load_dwordx4 v[120:123], v2, s[44:47], s7 offen nt
  s_addk_i32 s7, 8192
  buffer_load_dwordx4 v[124:127], v2, s[44:47], s7 offen nt
  s_addk_i32 s7, 8192
  buffer_load_dwordx4 v[128:131], v2, s[44:47], s7 offen nt
  s_addk_i32 s7, 8192
  buffer_load_dwordx4 v[132:135], v2, s[44:47], s7 offen nt
  s_lshr_b32 s57, s2, 3
  s_lshl_b32 s14, s6, 6
  s_and_b32 s59, s57, 1
  s_lshl_b32 s59, s59, 2
  s_add_u32 s14, s14, s59
  v_lshrrev_b32 v6, 4, v0
  v_lshl_add_u32 v6, v5, 3, v6
  v_add_lshl_u32 v6, v6, s14, 1
  buffer_load_ushort v7, v6, s[40:43], 0 offen
  s_and_b32 s5, s2, 7
  s_lshl_b32 s5, s5, 1
  s_bfe_u32 s14, s2, 0x10003
  s_add_u32 s5, s5, s14
  s_lshl_b32 s4, s5, 4
  s_add_u32 s4, s4, s6
  s_mov_b32 s60, s38
  s_mov_b32 s61, s39
  s_mov_b32 s62, 0x10000000
  s_mov_b32 s63, 0x20000
  s_mov_b32 s48, s34
  s_mov_b32 s49, s35
  s_mov_b32 s50, 0x480
  s_mov_b32 s51, 0x20000
  s_mov_b32 s9, 0x3fb8aa3b
  s_mov_b32 s13, 0xffff0000
  v_mov_b32 v35, 0
  v_and_b32 v28, 1, v0
  v_lshlrev_b32 v28, 4, v28
  v_mov_b32 v29, 0xffff
  v_lshlrev_b32 v29, v28, v29
  v_mov_b32 v36, 0
  v_mov_b32 v37, 0
  v_mov_b32 v38, 0
  v_mov_b32 v39, 0
  s_mov_b32 exec_lo, 0x3030303
  s_mov_b32 exec_hi, 0x3030303
  v_mov_b32 v36, v29
  s_mov_b32 exec_lo, 0xc0c0c0c
  s_mov_b32 exec_hi, 0xc0c0c0c
  v_mov_b32 v37, v29
  s_mov_b32 exec_lo, 0x30303030
  s_mov_b32 exec_hi, 0x30303030
  v_mov_b32 v38, v29
  s_mov_b32 exec_lo, 0xc0c0c0c0
  s_mov_b32 exec_hi, 0xc0c0c0c0
  v_mov_b32 v39, v29
  s_mov_b64 exec, -1
  s_getreg_b32 s56, hwreg(HW_REG_XCC_ID)
  s_mul_i32 s58, s4, 1280
  s_add_u32 s58, s58, 131072
  s_and_b32 s98, s2, 7
  s_lshl_b32 s28, s98, 8
  s_add_u32 s28, s28, 32768
  s_cmp_eq_u32 s57, 5
  s_cselect_b32 s28, s28, 0x40000000
  s_min_u32 s26, s57, 17
  s_mul_i32 s26, s26, 4608
  s_add_u32 s26, s26, 1179648
  s_xor_b32 s14, s57, s2
  s_and_b32 s14, s14, 7
  s_cselect_b32 s27, 0x40000000, s26
  s_cmp_ge_u32 s57, 18
  s_cselect_b32 s27, 0x40000000, s27
  v_mov_b32 v144, 0
  v_mov_b32 v145, 0
  v_mov_b32 v146, 0
  v_mov_b32 v147, 0
  v_lshrrev_b32 v148, 2, v0
  v_mul_u32_u24 v148, 0, v148
  v_add_u32 v148, v148, v1
  s_mov_b64 exec, 0xffff
  buffer_store_dwordx4 v[144:147], v148, s[60:63], s27 offen sc1
  s_mov_b64 exec, -1
  s_waitcnt lgkmcnt(0)
  s_mul_i32 s8, s8, 1664525
  s_add_u32 s8, s8, 1013904223
  s_lshr_b32 s14, s8, 8
  v_not_b32 v58, s8
  v_mov_b32 v59, s14
  v_mov_b32 v60, s56
  v_mov_b32 v61, s8
  v_not_b32 v62, s8
  v_not_b32 v63, s8
  buffer_store_dwordx4 v[58:61], v1, s[60:63], s58 offen
  v_lshlrev_b32 v28, 2, v0
  s_mov_b32 exec_hi, 0
  buffer_store_dword v61, v28, s[60:63], s28 offen
  s_mov_b64 exec, 0xff
  buffer_store_dwordx4 v[60:63], v1, s[60:63], s58 offen offset:1024
  s_mov_b64 exec, -1
  s_barrier
  s_waitcnt vmcnt(23)
  v_lshlrev_b32 v16, 16, v8
  v_and_b32 v17, s13, v8
  v_lshlrev_b32 v18, 16, v9
  v_and_b32 v19, s13, v9
  v_lshlrev_b32 v20, 16, v10
  v_and_b32 v21, s13, v10
  v_lshlrev_b32 v22, 16, v11
  v_and_b32 v23, s13, v11
  v_lshlrev_b32 v24, 16, v12
  v_add_f32 v28, v16, v17
  v_add_f32 v28, v28, v18
  v_add_f32 v28, v28, v19
  v_add_f32 v28, v28, v20
  v_add_f32 v28, v28, v21
  v_add_f32 v28, v28, v22
  v_add_f32 v28, v28, v23
  v_add_f32 v28, v28, v24
  s_nop 1
  v_add_f32_dpp v28, v28, v28 row_ror:1 row_mask:0xf bank_mask:0xf
  s_nop 1
  v_add_f32_dpp v28, v28, v28 row_ror:2 row_mask:0xf bank_mask:0xf
  s_nop 1
  v_add_f32_dpp v28, v28, v28 row_ror:4 row_mask:0xf bank_mask:0xf
  s_nop 1
  v_add_f32_dpp v28, v28, v28 row_ror:8 row_mask:0xf bank_mask:0xf
  v_mov_b32 v29, v28
  s_nop 1
  v_permlane16_swap_b32 v28, v29
  v_add_f32 v28, v28, v29
  v_mov_b32 v29, v28
  s_nop 1
  v_permlane32_swap_b32 v28, v29
  v_add_f32 v28, v28, v29
  v_mul_f32 v28, 0x3ae38e39, v28
  v_mov_b32 v30, 0
  v_sub_f32 v31, v16, v28
  v_fmac_f32 v30, v31, v31
  v_sub_f32 v32, v17, v28
  v_fmac_f32 v30, v32, v32
  v_sub_f32 v31, v18, v28
  v_fmac_f32 v30, v31, v31
  v_sub_f32 v32, v19, v28
  v_fmac_f32 v30, v32, v32
  v_sub_f32 v31, v20, v28
  v_fmac_f32 v30, v31, v31
  v_sub_f32 v32, v21, v28
  v_fmac_f32 v30, v32, v32
  v_sub_f32 v31, v22, v28
  v_fmac_f32 v30, v31, v31
  v_sub_f32 v32, v23, v28
  v_fmac_f32 v30, v32, v32
  v_sub_f32 v31, v24, v28
  v_fmac_f32 v30, v31, v31
  s_nop 1
  v_add_f32_dpp v30, v30, v30 row_ror:1 row_mask:0xf bank_mask:0xf
  s_nop 1
  v_add_f32_dpp v30, v30, v30 row_ror:2 row_mask:0xf bank_mask:0xf
  s_nop 1
  v_add_f32_dpp v30, v30, v30 row_ror:4 row_mask:0xf bank_mask:0xf
  s_nop 1
  v_add_f32_dpp v30, v30, v30 row_ror:8 row_mask:0xf bank_mask:0xf
  v_mov_b32 v29, v30
  s_nop 1
  v_permlane16_swap_b32 v30, v29
  v_add_f32 v30, v30, v29
  v_mov_b32 v29, v30
  s_nop 1
  v_permlane32_swap_b32 v30, v29
  v_add_f32 v30, v30, v29
  v_mul_f32 v30, 0x3ae38e39, v30
  v_cvt_pk_bf16_f32 v29, v28, v30
  v_lshlrev_b32 v28, 16, v29
  v_and_b32 v30, s13, v29
  v_add_f32 v30, 0x3727c5ac, v30
  v_cvt_pk_bf16_f32 v30, v30, v30
  v_and_b32 v30, s13, v30
  v_sqrt_f32 v30, v30
  v_sub_f32 v16, v16, v28
  v_sub_f32 v17, v17, v28
  v_sub_f32 v18, v18, v28
  v_sub_f32 v19, v19, v28
  v_sub_f32 v20, v20, v28
  v_sub_f32 v21, v21, v28
  v_sub_f32 v22, v22, v28
  v_sub_f32 v23, v23, v28
  v_sub_f32 v24, v24, v28
  v_cvt_pk_bf16_f32 v30, v30, v30
  v_and_b32 v30, s13, v30
  v_rcp_f32 v30, v30
  v_cvt_pk_bf16_f32 v8, v16, v17
  v_cvt_pk_bf16_f32 v9, v18, v19
  v_cvt_pk_bf16_f32 v10, v20, v21
  v_cvt_pk_bf16_f32 v11, v22, v23
  v_cvt_pk_bf16_f32 v12, v24, v24
  v_lshlrev_b32 v16, 16, v8
  v_and_b32 v17, s13, v8
  v_lshlrev_b32 v18, 16, v9
  v_and_b32 v19, s13, v9
  v_lshlrev_b32 v20, 16, v10
  v_and_b32 v21, s13, v10
  v_lshlrev_b32 v22, 16, v11
  v_and_b32 v23, s13, v11
  v_lshlrev_b32 v24, 16, v12
  v_mul_f32 v16, v16, v30
  v_mul_f32 v17, v17, v30
  v_mul_f32 v18, v18, v30
  v_mul_f32 v19, v19, v30
  v_mul_f32 v20, v20, v30
  v_mul_f32 v21, v21, v30
  v_mul_f32 v22, v22, v30
  v_mul_f32 v23, v23, v30
  v_mul_f32 v24, v24, v30
  v_cvt_pk_bf16_f32 v16, v16, v16
  v_cvt_pk_bf16_f32 v17, v17, v17
  v_cvt_pk_bf16_f32 v18, v18, v18
  v_cvt_pk_bf16_f32 v19, v19, v19
  v_cvt_pk_bf16_f32 v20, v20, v20
  v_cvt_pk_bf16_f32 v21, v21, v21
  v_cvt_pk_bf16_f32 v22, v22, v22
  v_cvt_pk_bf16_f32 v23, v23, v23
  v_cvt_pk_bf16_f32 v24, v24, v24
  v_lshlrev_b32 v28, 5, v0
  v_lshlrev_b32 v29, 2, v0
  ds_write_b128 v28, v[16:19] offset:0
  ds_write_b128 v28, v[20:23] offset:16
  ds_write_b32 v29, v24 offset:2048
  v_mov_b32 v32, 1
  ds_write_b32 v35, v32 offset:2820
  v_mul_u32_u24 v28, 72, v4
  s_mul_i32 s14, s15, 576
  v_add_u32 v28, s14, v28
  ds_read_b64 v[40:41], v28 offset:0
  ds_read_b64 v[42:43], v28 offset:8
  ds_read_b64 v[44:45], v28 offset:16
  ds_read_b64 v[46:47], v28 offset:24
  ds_read_b64 v[48:49], v28 offset:32
  ds_read_b64 v[50:51], v28 offset:40
  ds_read_b64 v[52:53], v28 offset:48
  ds_read_b64 v[54:55], v28 offset:56
  ds_read_b64 v[56:57], v28 offset:64
  s_waitcnt lgkmcnt(0)
  v_and_b32 v8, v36, v40
  v_and_b32 v9, v37, v40
  v_and_b32 v10, v38, v40
  v_and_b32 v11, v39, v40
  s_waitcnt vmcnt(22)
  s_nop 0
  v_mfma_f32_16x16x32_bf16 v[16:19], v[8:11], v[64:67], 0
  v_and_b32 v12, v36, v41
  v_and_b32 v13, v37, v41
  v_and_b32 v14, v38, v41
  v_and_b32 v15, v39, v41
  s_waitcnt vmcnt(21)
  s_nop 0
  v_mfma_f32_16x16x32_bf16 v[16:19], v[12:15], v[68:71], v[16:19]
  v_and_b32 v8, v36, v42
  v_and_b32 v9, v37, v42
  v_and_b32 v10, v38, v42
  v_and_b32 v11, v39, v42
  s_waitcnt vmcnt(20)
  s_nop 0
  v_mfma_f32_16x16x32_bf16 v[16:19], v[8:11], v[72:75], v[16:19]
  v_and_b32 v12, v36, v43
  v_and_b32 v13, v37, v43
  v_and_b32 v14, v38, v43
  v_and_b32 v15, v39, v43
  s_waitcnt vmcnt(19)
  s_nop 0
  v_mfma_f32_16x16x32_bf16 v[16:19], v[12:15], v[76:79], v[16:19]
  v_and_b32 v8, v36, v44
  v_and_b32 v9, v37, v44
  v_and_b32 v10, v38, v44
  v_and_b32 v11, v39, v44
  s_waitcnt vmcnt(18)
  s_nop 0
  v_mfma_f32_16x16x32_bf16 v[16:19], v[8:11], v[80:83], v[16:19]
  v_and_b32 v12, v36, v45
  v_and_b32 v13, v37, v45
  v_and_b32 v14, v38, v45
  v_and_b32 v15, v39, v45
  s_waitcnt vmcnt(17)
  s_nop 0
  v_mfma_f32_16x16x32_bf16 v[16:19], v[12:15], v[84:87], v[16:19]
  v_and_b32 v8, v36, v46
  v_and_b32 v9, v37, v46
  v_and_b32 v10, v38, v46
  v_and_b32 v11, v39, v46
  s_waitcnt vmcnt(16)
  s_nop 0
  v_mfma_f32_16x16x32_bf16 v[16:19], v[8:11], v[88:91], v[16:19]
  v_and_b32 v12, v36, v47
  v_and_b32 v13, v37, v47
  v_and_b32 v14, v38, v47
  v_and_b32 v15, v39, v47
  s_waitcnt vmcnt(15)
  s_nop 0
  v_mfma_f32_16x16x32_bf16 v[16:19], v[12:15], v[92:95], v[16:19]
  v_and_b32 v8, v36, v48
  v_and_b32 v9, v37, v48
  v_and_b32 v10, v38, v48
  v_and_b32 v11, v39, v48
  s_waitcnt vmcnt(14)
  s_nop 0
  v_mfma_f32_16x16x32_bf16 v[16:19], v[8:11], v[96:99], v[16:19]
  v_and_b32 v12, v36, v49
  v_and_b32 v13, v37, v49
  v_and_b32 v14, v38, v49
  v_and_b32 v15, v39, v49
  s_waitcnt vmcnt(13)
  s_nop 0
  v_mfma_f32_16x16x32_bf16 v[16:19], v[12:15], v[100:103], v[16:19]
  v_and_b32 v8, v36, v50
  v_and_b32 v9, v37, v50
  v_and_b32 v10, v38, v50
  v_and_b32 v11, v39, v50
  s_waitcnt vmcnt(12)
  s_nop 0
  v_mfma_f32_16x16x32_bf16 v[16:19], v[8:11], v[104:107], v[16:19]
  v_and_b32 v12, v36, v51
  v_and_b32 v13, v37, v51
  v_and_b32 v14, v38, v51
  v_and_b32 v15, v39, v51
  s_waitcnt vmcnt(11)
  s_nop 0
  v_mfma_f32_16x16x32_bf16 v[16:19], v[12:15], v[108:111], v[16:19]
  v_and_b32 v8, v36, v52
  v_and_b32 v9, v37, v52
  v_and_b32 v10, v38, v52
  v_and_b32 v11, v39, v52
  s_waitcnt vmcnt(10)
  s_nop 0
  v_mfma_f32_16x16x32_bf16 v[16:19], v[8:11], v[112:115], v[16:19]
  v_and_b32 v12, v36, v53
  v_and_b32 v13, v37, v53
  v_and_b32 v14, v38, v53
  v_and_b32 v15, v39, v53
  s_waitcnt vmcnt(9)
  s_nop 0
  v_mfma_f32_16x16x32_bf16 v[16:19], v[12:15], v[116:119], v[16:19]
  v_and_b32 v8, v36, v54
  v_and_b32 v9, v37, v54
  v_and_b32 v10, v38, v54
  v_and_b32 v11, v39, v54
  s_waitcnt vmcnt(8)
  s_nop 0
  v_mfma_f32_16x16x32_bf16 v[16:19], v[8:11], v[120:123], v[16:19]
  v_and_b32 v12, v36, v55
  v_and_b32 v13, v37, v55
  v_and_b32 v14, v38, v55
  v_and_b32 v15, v39, v55
  s_waitcnt vmcnt(7)
  s_nop 0
  v_mfma_f32_16x16x32_bf16 v[16:19], v[12:15], v[124:127], v[16:19]
  v_and_b32 v8, v36, v56
  v_and_b32 v9, v37, v56
  v_and_b32 v10, v38, v56
  v_and_b32 v11, v39, v56
  s_waitcnt vmcnt(6)
  s_nop 0
  v_mfma_f32_16x16x32_bf16 v[16:19], v[8:11], v[128:131], v[16:19]
  v_and_b32 v12, v36, v57
  v_and_b32 v13, v37, v57
  v_and_b32 v14, v38, v57
  v_and_b32 v15, v39, v57
  s_waitcnt vmcnt(5)
  s_nop 0
  v_mfma_f32_16x16x32_bf16 v[16:19], v[12:15], v[132:135], v[16:19]
  v_lshlrev_b32 v28, 5, v5
  v_and_b32 v29, 16, v0
  v_add_u32 v28, v28, v29
  s_nop 4
  v_permlane32_swap_b32 v16, v20
  v_permlane32_swap_b32 v17, v21
  v_permlane32_swap_b32 v18, v22
  v_permlane32_swap_b32 v19, v23
  v_add_f32_dpp v8, v20, v16 row_ror:8 row_mask:0xf bank_mask:0xf
  v_add_f32_dpp v9, v21, v17 row_ror:8 row_mask:0xf bank_mask:0xf
  v_add_f32_dpp v10, v22, v18 row_ror:8 row_mask:0xf bank_mask:0xf
  v_add_f32_dpp v11, v23, v19 row_ror:8 row_mask:0xf bank_mask:0xf
  v_add_u32 v8, 0x80, v8
  v_add_u32 v9, 0x80, v9
  v_add_u32 v10, 0x80, v10
  v_add_u32 v11, 0x80, v11
  v_mov_b32_sdwa v8, s8 dst_sel:BYTE_0 dst_unused:UNUSED_PRESERVE src0_sel:BYTE_0
  v_mov_b32_sdwa v9, s8 dst_sel:BYTE_0 dst_unused:UNUSED_PRESERVE src0_sel:BYTE_1
  v_mov_b32_sdwa v10, s8 dst_sel:BYTE_0 dst_unused:UNUSED_PRESERVE src0_sel:BYTE_2
  v_mov_b32_sdwa v11, s8 dst_sel:BYTE_0 dst_unused:UNUSED_PRESERVE src0_sel:BYTE_3
  s_mov_b64 exec, 0x00ff00ff
  buffer_store_dwordx4 v[8:11], v28, s[60:63], s58 offen
  s_mov_b64 exec, -1
  s_mov_b32 s99, 1
  s_mul_i32 s59, s5, 20480
  s_add_u32 s59, s59, 131072
  s_mov_b32 s96, 0
  v_lshrrev_b32 v29, 4, v0
  v_mul_u32_u24 v29, 5120, v29
  v_and_b32 v30, 15, v0
  v_lshl_add_u32 v29, v30, 4, v29
  v_lshrrev_b32 v31, 5, v0
  s_bfe_u32 s52, s8, 0x80000
  s_bfe_u32 s53, s8, 0x80008
  s_bfe_u32 s54, s8, 0x80010
  s_bfe_u32 s55, s8, 0x80018
  v_lshrrev_b32 v33, 1, v0
  v_mul_u32_u24 v33, 1280, v33
  s_mul_i32 s100, s98, 40960
  s_add_u32 s100, s100, 131072
  s_mov_b32 s96, 0
L_xspin:
  s_sleep 2
  ds_read_b32 v30, v35 offset:2844
  s_add_u32 s96, s96, 1
  s_cmp_gt_u32 s96, 1000000
  s_cbranch_scc1 L_xspin_done
  s_waitcnt lgkmcnt(0)
  v_cmp_gt_u32 vcc, 20, v30
  s_cbranch_vccnz L_xspin
L_xspin_done:
  s_mov_b32 s96, 0
L_pollq:
  buffer_load_dwordx4 v[64:67], v29, s[60:63], s59 offen offset:0 sc1
  buffer_load_dwordx4 v[68:71], v29, s[60:63], s59 offen offset:1280 sc1
  buffer_load_dwordx4 v[72:75], v29, s[60:63], s59 offen offset:2560 sc1
  buffer_load_dwordx4 v[76:79], v29, s[60:63], s59 offen offset:3840 sc1
  buffer_load_dwordx2 v[96:97], v33, s[60:63], s100 offen offset:1024 sc1
  s_add_u32 s96, s96, 1
  s_cmp_gt_u32 s96, 50000
  s_cbranch_scc1 L_q_done
  s_waitcnt vmcnt(0)
  s_mov_b64 s[44:45], 0
  v_xor_b32 v64, s52, v64
  v_xor_b32 v65, s53, v65
  v_xor_b32 v66, s54, v66
  v_xor_b32 v67, s55, v67
  v_or3_b32 v30, v64, v65, v66
  v_or_b32 v30, v30, v67
  v_cmp_ne_u32_sdwa s[42:43], v30, 0 src0_sel:BYTE_0 src1_sel:DWORD
  s_nop 0
  s_or_b64 s[44:45], s[44:45], s[42:43]
  v_xor_b32 v68, s52, v68
  v_xor_b32 v69, s53, v69
  v_xor_b32 v70, s54, v70
  v_xor_b32 v71, s55, v71
  v_or3_b32 v30, v68, v69, v70
  v_or_b32 v30, v30, v71
  v_cmp_ne_u32_sdwa s[42:43], v30, 0 src0_sel:BYTE_0 src1_sel:DWORD
  s_nop 0
  s_or_b64 s[44:45], s[44:45], s[42:43]
  v_xor_b32 v72, s52, v72
  v_xor_b32 v73, s53, v73
  v_xor_b32 v74, s54, v74
  v_xor_b32 v75, s55, v75
  v_or3_b32 v30, v72, v73, v74
  v_or_b32 v30, v30, v75
  v_cmp_ne_u32_sdwa s[42:43], v30, 0 src0_sel:BYTE_0 src1_sel:DWORD
  s_nop 0
  s_or_b64 s[44:45], s[44:45], s[42:43]
  v_xor_b32 v76, s52, v76
  v_xor_b32 v77, s53, v77
  v_xor_b32 v78, s54, v78
  v_xor_b32 v79, s55, v79
  v_or3_b32 v30, v76, v77, v78
  v_or_b32 v30, v30, v79
  v_cmp_ne_u32_sdwa s[42:43], v30, 0 src0_sel:BYTE_0 src1_sel:DWORD
  s_nop 0
  s_or_b64 s[44:45], s[44:45], s[42:43]
  v_cmp_ne_u32 vcc, s8, v97
  v_cmp_ne_u32 s[20:21], s56, v96
  s_nop 0
  s_andn2_b64 s[40:41], s[20:21], vcc
  s_or_b64 vcc, vcc, s[44:45]
  s_cmp_eq_u32 s99, 0
  s_cbranch_scc1 L_q_test
  s_cmp_lg_u64 s[40:41], 0
  s_cbranch_scc1 L_q_wt
  s_cmp_lt_u32 s96, 8
  s_cbranch_scc0 L_q_wt
L_q_test:
  s_cbranch_vccnz L_pollq
L_q_done:
  v_add_f32 v64, v64, v68
  v_add_f32 v65, v65, v69
  v_add_f32 v66, v66, v70
  v_add_f32 v67, v67, v71
  v_add_f32 v64, v64, v72
  v_add_f32 v65, v65, v73
  v_add_f32 v66, v66, v74
  v_add_f32 v67, v67, v75
  v_add_f32 v64, v64, v76
  v_add_f32 v65, v65, v77
  v_add_f32 v66, v66, v78
  v_add_f32 v67, v67, v79
  v_cvt_pk_bf16_f32 v16, v64, v65
  v_cvt_pk_bf16_f32 v17, v66, v67
  v_lshlrev_b32 v29, 3, v0
  s_add_u32 s14, s99, 2
  v_mov_b32 v32, s14
  ds_write_b64 v29, v[16:17] offset:2304
  ds_write_b32 v35, v32 offset:2820
  s_min_u32 s14, s57, 17
  s_lshl_b32 s14, s14, 2
  v_mov_b32 v149, s14
  s_waitcnt vmcnt(0)
  s_cmp_eq_u32 s27, 0x40000000
  s_cbranch_scc1 L_noz
  s_mov_b64 exec, 1
  global_store_dword v149, v32, s[36:37] sc1
  s_mov_b64 exec, -1
L_noz:
  s_mov_b32 s96, 0
L_gspin:
  s_sleep 2
  ds_read_b32 v28, v35 offset:2832
  s_add_u32 s96, s96, 1
  s_cmp_gt_u32 s96, 1000000
  s_cbranch_scc1 L_gspin_done
  s_waitcnt lgkmcnt(0)
  v_cmp_gt_u32 vcc, 4, v28
  s_cbranch_vccnz L_gspin
L_gspin_done:
  ds_read_b128 v[64:67], v1 offset:4096
  ds_read_b128 v[68:71], v1 offset:5120
  ds_read_b128 v[72:75], v1 offset:6144
  s_mul_i32 s7, s57, 18432
  s_mul_i32 s14, s98, 2304
  s_add_u32 s7, s7, s14
  s_add_u32 s7, s7, 524288
  v_mov_b32 v28, 0x40000000
  s_mov_b64 exec, 0xffff
  v_mov_b32 v28, v1
  s_mov_b64 exec, -1
  s_waitcnt lgkmcnt(0)
  s_cmp_eq_u32 s99, 0
  s_cbranch_scc1 L_wt5
  buffer_store_dwordx4 v[64:67], v1, s[60:63], s7 offen
  buffer_store_dwordx4 v[68:71], v1, s[60:63], s7 offen offset:1024
  buffer_store_dwordx4 v[72:75], v28, s[60:63], s7 offen offset:2048
L_wb5:
  s_waitcnt vmcnt(0)
  s_mov_b32 s96, 0
L_mlspin:
  s_sleep 4
  ds_read_b32 v28, v35 offset:2824
  s_add_u32 s96, s96, 1
  s_cmp_gt_u32 s96, 1000000
  s_cbranch_scc1 L_mlspin_done
  s_waitcnt lgkmcnt(0)
  v_cmp_gt_u32 vcc, 4, v28
  s_cbranch_vccnz L_mlspin
L_mlspin_done:
  v_mul_u32_u24 v29, 18432, v4
  v_lshl_add_u32 v29, v5, 4, v29
  v_lshrrev_b32 v30, 4, v0
  s_mul_i32 s7, s4, 72
  s_and_b32 s7, s7, -16
  s_add_u32 s7, s7, 524288
  s_add_u32 s14, s7, 147456
  s_add_u32 s15, s7, 294912
  s_add_u32 s97, s7, 442368
  s_mov_b32 s96, 0
  v_mov_b32 v64, 0
  v_mov_b32 v65, 0
  v_mov_b32 v66, 0
  v_mov_b32 v67, 0
  v_mov_b32 v68, 0
  v_mov_b32 v69, 0
  v_mov_b32 v70, 0
  v_mov_b32 v71, 0
  v_mov_b32 v72, 0
  v_mov_b32 v73, 0
  v_mov_b32 v74, 0
  v_mov_b32 v75, 0
  v_mov_b32 v76, 0
  v_mov_b32 v77, 0
  v_mov_b32 v78, 0
  v_mov_b32 v79, 0
  s_mov_b32 exec_lo, 0x1f1f1f1f
  s_mov_b32 exec_hi, 0x1f1f1f1f
L_pollg:
  buffer_load_dwordx4 v[64:67], v29, s[60:63], s7 offen sc1
  buffer_load_dwordx4 v[68:71], v29, s[60:63], s14 offen sc1
  buffer_load_dwordx4 v[72:75], v29, s[60:63], s15 offen sc1
  buffer_load_dwordx4 v[76:79], v29, s[60:63], s97 offen sc1
  s_add_u32 s96, s96, 1
  s_cmp_gt_u32 s96, 50000
  s_cbranch_scc1 L_g_done
  s_waitcnt vmcnt(0)
  v_xor_b32 v64, s52, v64
  v_xor_b32 v65, s53, v65
  v_xor_b32 v66, s54, v66
  v_xor_b32 v67, s55, v67
  v_or3_b32 v28, v64, v65, v66
  v_or_b32 v28, v28, v67
  v_cmp_ne_u32_sdwa s[40:41], v28, 0 src0_sel:BYTE_0 src1_sel:DWORD
  v_xor_b32 v68, s52, v68
  v_xor_b32 v69, s53, v69
  v_xor_b32 v70, s54, v70
  v_xor_b32 v71, s55, v71
  v_or3_b32 v28, v68, v69, v70
  v_or_b32 v28, v28, v71
  v_cmp_ne_u32_sdwa s[42:43], v28, 0 src0_sel:BYTE_0 src1_sel:DWORD
  v_xor_b32 v72, s52, v72
  v_xor_b32 v73, s53, v73
  v_xor_b32 v74, s54, v74
  v_xor_b32 v75, s55, v75
  v_or3_b32 v28, v72, v73, v74
  v_or_b32 v28, v28, v75
  v_cmp_ne_u32_sdwa s[44:45], v28, 0 src0_sel:BYTE_0 src1_sel:DWORD
  v_xor_b32 v76, s52, v76
  v_xor_b32 v77, s53, v77
  v_xor_b32 v78, s54, v78
  v_xor_b32 v79, s55, v79
  v_or3_b32 v28, v76, v77, v78
  v_or_b32 v28, v28, v79
  v_cmp_ne_u32_sdwa vcc, v28, 0 src0_sel:BYTE_0 src1_sel:DWORD
  s_or_b64 s[40:41], s[40:41], s[42:43]
  s_or_b64 vcc, vcc, s[44:45]
  s_or_b64 vcc, vcc, s[40:41]
  s_cbranch_scc1 L_pollg
L_g_done:
  s_mov_b64 exec, -1
  v_add_f32 v64, v64, v68
  v_add_f32 v65, v65, v69
  v_add_f32 v66, v66, v70
  v_add_f32 v67, v67, v71
  v_add_f32 v64, v64, v72
  v_add_f32 v65, v65, v73
  v_add_f32 v66, v66, v74
  v_add_f32 v67, v67, v75
  v_add_f32 v64, v64, v76
  v_add_f32 v65, v65, v77
  v_add_f32 v66, v66, v78
  v_add_f32 v67, v67, v79
  s_nop 0
  v_permlane32_swap_b32 v64, v66
  v_permlane32_swap_b32 v65, v67
  v_add_f32 v64, v64, v66
  v_add_f32 v65, v65, v67
  s_nop 1
  v_permlane16_swap_b32 v64, v65
  v_add_f32 v64, v64, v65
  v_cvt_pk_bf16_f32 v64, v64, v64
  v_and_b32 v64, s13, v64
  v_mul_f32 v65, s9, v64
  v_exp_f32 v65, -v65
  s_nop 0
  v_add_f32 v65, 1.0, v65
  v_rcp_f32 v65, v65
  s_nop 0
  v_mul_f32 v65, v64, v65
  v_cvt_pk_bf16_f32 v65, v65, v65
  v_and_b32 v65, s13, v65
  s_nop 1
  v_mul_f32_dpp v65, v64, v65 row_ror:8 row_mask:0xf bank_mask:0xf
  v_cvt_pk_bf16_f32 v65, v65, v65
  v_lshl_add_u32 v29, v5, 2, v30
  v_lshlrev_b32 v29, 2, v29
  s_mov_b32 exec_lo, 0x00ff00ff
  s_mov_b32 exec_hi, 0x00ff00ff
  ds_write_b32 v29, v65 offset:3328
  s_mov_b64 exec, -1
  ds_write_b32 v35, v32 offset:2828
  v_lshlrev_b32 v29, 5, v31
  ds_read_b128 v[40:43], v29 offset:3200
  ds_read_b128 v[44:47], v29 offset:3216
  v_and_b32 v28, 3, v0
  v_lshlrev_b32 v28, 5, v28
  v_lshl_add_u32 v28, v31, 4, v28
  v_mov_b32 v50, s8
  v_mov_b32 v51, s8
  s_waitcnt lgkmcnt(0)
  v_max3_f32 v48, v40, v42, v44
  v_max_f32 v48, v48, v46
  v_sub_f32 v52, v40, v48
  v_sub_f32 v53, v42, v48
  v_sub_f32 v54, v44, v48
  v_sub_f32 v55, v46, v48
  v_mul_f32 v52, s9, v52
  v_mul_f32 v53, s9, v53
  v_mul_f32 v54, s9, v54
  v_mul_f32 v55, s9, v55
  v_exp_f32 v52, v52
  v_exp_f32 v53, v53
  v_exp_f32 v54, v54
  v_exp_f32 v55, v55
  v_mul_f32 v49, v52, v41
  v_fmac_f32 v49, v53, v43
  v_fmac_f32 v49, v54, v45
  v_fmac_f32 v49, v55, v47
  s_mov_b32 exec_lo, 15
  s_mov_b32 exec_hi, 15
  s_cmp_eq_u32 s99, 0
  s_cbranch_scc1 L_wt6
  buffer_store_dwordx4 v[48:51], v28, s[60:63], s58 offen offset:1024
L_wb6:
  s_mov_b64 exec, -1
  s_and_b32 s14, s5, 1
  s_lshl_b32 s14, s14, 4
  v_and_b32 v29, 31, v0
  v_xor_b32 v29, s14, v29
  v_mul_u32_u24 v29, 1280, v29
  v_lshl_add_u32 v29, v31, 4, v29
  s_mov_b32 s96, 0
L_tspin:
  s_sleep 4
  ds_read_b32 v28, v35 offset:2836
  s_add_u32 s96, s96, 1
  s_cmp_gt_u32 s96, 1000000
  s_cbranch_scc1 L_tspin_done
  s_waitcnt lgkmcnt(0)
  v_cmp_gt_u32 vcc, 4, v28
  s_cbranch_vccnz L_tspin
L_tspin_done:
  s_mov_b32 s96, 0
L_pollm:
  buffer_load_dwordx4 v[40:43], v29, s[60:63], s100 offen offset:1024 sc1
  global_load_dword v44, v149, s[36:37] sc1
  s_add_u32 s96, s96, 1
  s_cmp_gt_u32 s96, 50000
  s_cbranch_scc1 L_m_done
  s_waitcnt vmcnt(0)
  v_cmp_ne_u32 vcc, s8, v42
  v_cmp_eq_u32 s[40:41], 0, v44
  s_nop 0
  s_or_b64 vcc, vcc, s[40:41]
  s_cbranch_scc0 L_m_done
  s_sleep 8
  s_branch L_pollm
L_m_done:
  v_mov_b32 v42, v40
  v_mov_b32 v43, v41
  s_nop 0
  v_permlane16_swap_b32 v40, v42
  v_permlane16_swap_b32 v41, v43
  v_mov_b32 v28, v40
  s_nop 1
  v_max_f32_dpp v28, v28, v28 row_ror:1 row_mask:0xf bank_mask:0xf
  s_nop 1
  v_max_f32_dpp v28, v28, v28 row_ror:2 row_mask:0xf bank_mask:0xf
  s_nop 1
  v_max_f32_dpp v28, v28, v28 row_ror:4 row_mask:0xf bank_mask:0xf
  s_nop 1
  v_max_f32_dpp v28, v28, v28 row_ror:8 row_mask:0xf bank_mask:0xf
  v_sub_f32 v40, v40, v28
  v_sub_f32 v48, v48, v28
  v_mul_f32 v40, s9, v40
  v_mul_f32 v48, s9, v48
  v_exp_f32 v40, v40
  v_exp_f32 v48, v48
  v_mul_f32 v40, v40, v41
  s_nop 1
  v_add_f32_dpp v40, v40, v40 row_ror:1 row_mask:0xf bank_mask:0xf
  s_nop 1
  v_add_f32_dpp v40, v40, v40 row_ror:2 row_mask:0xf bank_mask:0xf
  s_nop 1
  v_add_f32_dpp v40, v40, v40 row_ror:4 row_mask:0xf bank_mask:0xf
  s_nop 1
  v_add_f32_dpp v40, v40, v40 row_ror:8 row_mask:0xf bank_mask:0xf
  v_rcp_f32 v40, v40
  s_nop 0
  v_mul_f32 v48, v48, v40
  v_mul_f32 v104, v52, v48
  v_mul_f32 v105, v52, v48
  v_mul_f32 v106, v53, v48
  v_mul_f32 v107, v53, v48
  v_mul_f32 v108, v54, v48
  v_mul_f32 v109, v54, v48
  v_mul_f32 v110, v55, v48
  v_mul_f32 v111, v55, v48
  v_mul_u32_u24 v2, 36864, v4
  v_lshl_add_u32 v2, v5, 4, v2
  v_mov_b32 v80, 0
  v_mov_b32 v81, 0
  v_mov_b32 v82, 0
  v_mov_b32 v83, 0
  v_lshrrev_b32 v3, 4, v0
  v_mul_u32_u24 v3, 0, v3
  v_lshl_add_u32 v3, v0, 2, v3
  v_mov_b32 v100, 1.0
  v_mov_b32 v102, 0x40e00000
  v_lshlrev_b32 v7, 16, v7
  s_mul_i32 s7, s98, 2304
  s_lshl_b32 s14, s57, 7
  s_add_u32 s7, s7, s14
  s_add_u32 s7, s7, 524288
  s_not_b32 s24, s8
  s_xor_b32 s52, s52, 0xff
  s_xor_b32 s53, s53, 0xff
  s_xor_b32 s54, s54, 0xff
  s_xor_b32 s55, s55, 0xff
  s_add_u32 s14, s7, 294912
  s_add_u32 s15, s7, 18432
  s_add_u32 s97, s7, 313344
  s_mov_b64 s[40:41], -1
  s_mov_b64 s[42:43], -1
  s_mov_b64 s[44:45], -1
  s_mov_b64 s[46:47], -1
  s_mov_b32 s96, 0
L_ospin:
  ds_read_b32 v28, v35 offset:2816
  ds_read_b128 v[64:67], v1 offset:4096
  ds_read_b128 v[68:71], v1 offset:5120
  ds_read_b128 v[72:75], v1 offset:6144
  ds_read_b128 v[76:79], v1 offset:7168
  s_add_u32 s96, s96, 1
  s_cmp_gt_u32 s96, 1000000
  s_cbranch_scc1 L_ospin_done
  s_waitcnt lgkmcnt(0)
  v_cmp_gt_u32 vcc, 4, v28
  s_cbranch_vccnz L_ospin
L_ospin_done:
  v_pk_mul_f32 v[64:65], v[104:105], v[64:65]
  v_pk_mul_f32 v[66:67], v[104:105], v[66:67]
  v_pk_fma_f32 v[64:65], v[106:107], v[68:69], v[64:65]
  v_pk_fma_f32 v[66:67], v[106:107], v[70:71], v[66:67]
  v_pk_fma_f32 v[64:65], v[108:109], v[72:73], v[64:65]
  v_pk_fma_f32 v[66:67], v[108:109], v[74:75], v[66:67]
  v_pk_fma_f32 v[64:65], v[110:111], v[76:77], v[64:65]
  v_pk_fma_f32 v[66:67], v[110:111], v[78:79], v[66:67]
  v_mov_b32_sdwa v64, s24 dst_sel:BYTE_0 dst_unused:UNUSED_PRESERVE src0_sel:BYTE_0
  v_mov_b32_sdwa v65, s24 dst_sel:BYTE_0 dst_unused:UNUSED_PRESERVE src0_sel:BYTE_1
  v_mov_b32_sdwa v66, s24 dst_sel:BYTE_0 dst_unused:UNUSED_PRESERVE src0_sel:BYTE_2
  v_mov_b32_sdwa v67, s24 dst_sel:BYTE_0 dst_unused:UNUSED_PRESERVE src0_sel:BYTE_3
  s_cmp_eq_u32 s99, 0
  s_cbranch_scc1 L_wt7
  buffer_store_dwordx4 v[64:67], v1, s[60:63], s58 offen
L_wb7:
  s_barrier
  s_mov_b32 s96, 0
  s_barrier
  s_cmp_ge_u32 s57, 18
  s_cbranch_scc1 L_fin
L_poll2:
  s_mov_b64 exec, s[40:41]
  buffer_load_dwordx4 v[80:83], v2, s[60:63], s7 offen sc1
  s_mov_b64 exec, s[42:43]
  buffer_load_dwordx4 v[84:87], v2, s[60:63], s14 offen sc1
  s_mov_b64 exec, s[44:45]
  buffer_load_dwordx4 v[88:91], v2, s[60:63], s15 offen sc1
  s_mov_b64 exec, s[46:47]
  buffer_load_dwordx4 v[92:95], v2, s[60:63], s97 offen sc1
  s_add_u32 s96, s96, 1
  s_cmp_gt_u32 s96, 100000
  s_cbranch_scc1 L_2_done
  s_mov_b64 exec, s[40:41]
  s_cbranch_execz L_sk0
  s_waitcnt vmcnt(3)
  v_xor_b32 v80, s52, v80
  v_xor_b32 v81, s53, v81
  v_xor_b32 v82, s54, v82
  v_xor_b32 v83, s55, v83
  v_or3_b32 v28, v80, v81, v82
  v_or_b32 v28, v28, v83
  v_cmp_ne_u32_sdwa s[40:41], v28, 0 src0_sel:BYTE_0 src1_sel:DWORD
L_sk0:
  s_mov_b64 exec, s[42:43]
  s_cbranch_execz L_sk1
  s_waitcnt vmcnt(2)
  v_xor_b32 v84, s52, v84
  v_xor_b32 v85, s53, v85
  v_xor_b32 v86, s54, v86
  v_xor_b32 v87, s55, v87
  v_or3_b32 v28, v84, v85, v86
  v_or_b32 v28, v28, v87
  v_cmp_ne_u32_sdwa s[42:43], v28, 0 src0_sel:BYTE_0 src1_sel:DWORD
L_sk1:
  s_mov_b64 exec, s[44:45]
  s_cbranch_execz L_sk2
  s_waitcnt vmcnt(1)
  v_xor_b32 v88, s52, v88
  v_xor_b32 v89, s53, v89
  v_xor_b32 v90, s54, v90
  v_xor_b32 v91, s55, v91
  v_or3_b32 v28, v88, v89, v90
  v_or_b32 v28, v28, v91
  v_cmp_ne_u32_sdwa s[44:45], v28, 0 src0_sel:BYTE_0 src1_sel:DWORD
L_sk2:
  s_mov_b64 exec, s[46:47]
  s_cbranch_execz L_sk3
  s_waitcnt vmcnt(0)
  v_xor_b32 v92, s52, v92
  v_xor_b32 v93, s53, v93
  v_xor_b32 v94, s54, v94
  v_xor_b32 v95, s55, v95
  v_or3_b32 v28, v92, v93, v94
  v_or_b32 v28, v28, v95
  v_cmp_ne_u32_sdwa s[46:47], v28, 0 src0_sel:BYTE_0 src1_sel:DWORD
L_sk3:
  s_or_b64 s[20:21], s[40:41], s[42:43]
  s_or_b64 vcc, s[44:45], s[46:47]
  s_or_b64 vcc, vcc, s[20:21]
  s_cbranch_scc1 L_poll2
L_2_done:
  s_mov_b64 exec, -1
  v_pk_add_f32 v[80:81], v[80:81], v[88:89]
  v_pk_add_f32 v[82:83], v[82:83], v[90:91]
  v_pk_add_f32 v[84:85], v[84:85], v[92:93]
  v_pk_add_f32 v[86:87], v[86:87], v[94:95]
  v_pk_add_f32 v[80:81], v[80:81], v[84:85]
  v_pk_add_f32 v[82:83], v[82:83], v[86:87]
  s_nop 1
  v_permlane32_swap_b32 v80, v82
  v_permlane32_swap_b32 v81, v83
  v_add_f32 v80, v80, v82
  v_add_f32 v81, v81, v83
  s_nop 1
  v_permlane16_swap_b32 v80, v81
  v_add_f32 v80, v80, v81
  s_nop 1
  v_add_f32_dpp v100, v80, v80 row_ror:8 row_mask:0xf bank_mask:0x3
  s_mov_b32 exec_lo, 0x01ff01ff
  s_mov_b32 exec_hi, 0x01ff01ff
  v_add_f32 v7, v7, v100
  buffer_atomic_add_f32 v100, v3, s[60:63], s26 offen sc0
  s_waitcnt vmcnt(0)
  v_mov_b32_dpp v101, v100 row_newbcast:8 row_mask:0xf bank_mask:0xf
  v_add_f32 v100, v100, v7
  s_mov_b32 exec_lo, 0x00ff00ff
  s_mov_b32 exec_hi, 0x00ff00ff
  v_cmp_eq_f32 vcc, v101, v102
  v_cvt_pk_bf16_f32 v100, v100, v100
  s_and_b64 exec, exec, vcc
  s_cbranch_scc0 L_fin
  buffer_store_short v100, v6, s[48:51], 0 offen
  s_cmp_lg_u32 s57, 0
  s_cbranch_scc1 L_fin
  s_and_b64 exec, exec, 1
  s_cbranch_scc0 L_fin
  v_mov_b32 v28, s8
  buffer_store_dword v28, v0, s[60:63], 0 offen
L_fin:
L_end:
  s_endpgm
L_C:
  v_mov_b32 v4, 0
  v_mov_b32 v5, 0
  v_mov_b32 v6, 0
  v_mov_b32 v7, 0
  s_mov_b64 exec, 1
  v_mov_b32 v1, 0
  ds_write_b128 v1, v[4:7] offset:2816
  ds_write_b128 v1, v[4:7] offset:2832
  s_waitcnt lgkmcnt(0)
  s_load_dword s8, s[38:39], 0
  s_barrier
  s_mov_b32 s60, s38
  s_mov_b32 s61, s39
  s_mov_b32 s62, 0x10000000
  s_mov_b32 s63, 0x20000
  v_mov_b32 v3, 0x80000000
  s_and_b32 s40, s2, 7
  s_lshl_b32 s40, s40, 8
  s_add_u32 s40, s40, 32768
  s_mov_b32 s96, 0
L_cq:
  s_sleep 8
  ds_read_b32 v2, v1 offset:2820
  s_add_u32 s96, s96, 1
  s_cmp_gt_u32 s96, 1000000
  s_cbranch_scc1 L_cq_done
  s_waitcnt lgkmcnt(0)
  v_cmp_gt_u32 vcc, 2, v2
  s_cbranch_vccnz L_cq
L_cq_done:
  s_mul_i32 s8, s8, 1664525
  s_add_u32 s8, s8, 1013904223
  v_readfirstlane_b32 s43, v2
  s_mov_b32 s44, 0
  s_mov_b32 s96, 0
  s_bitcmp0_b32 s43, 0
  s_cbranch_scc1 L_cend
L_cloop:
  s_sleep 2
  ds_read_b32 v2, v1 offset:2844
  s_add_u32 s96, s96, 1
  s_cmp_gt_u32 s96, 1000000
  s_cbranch_scc1 L_cend
  s_waitcnt lgkmcnt(0)
  v_readfirstlane_b32 s43, v2
  s_nop 0
  s_and_b32 s43, s43, 0x7fffffff
  s_cmp_ge_u32 s43, 232
  s_cbranch_scc1 L_cend
  s_cmp_lt_u32 s43, s44
  s_cbranch_scc1 L_cloop
  buffer_load_dword v4, v1, s[60:63], s40 offen sc1
  s_add_u32 s44, s43, 4
  s_waitcnt vmcnt(0)
  v_readfirstlane_b32 s46, v4
  ds_read_b32 v2, v1 offset:2844
  s_sub_u32 s46, s46, s8
  s_cmp_gt_u32 s43, s46
  s_cselect_b32 s47, s40, 0x40000000
  s_waitcnt lgkmcnt(0)
  v_and_b32 v2, 0x7fffffff, v2
  v_add_u32 v2, s8, v2
  buffer_store_dword v2, v1, s[60:63], s47 offen
  s_add_u32 s43, s43, 2
  s_cmp_gt_u32 s46, s43
  s_cselect_b32 s46, 0, 0x80000000
  v_mov_b32 v4, s46
  ds_mskor_b32 v1, v3, v4 offset:2844
  s_branch L_cloop
L_cend:
  s_endpgm
L_S1:
  s_waitcnt lgkmcnt(0)
  s_load_dword s8, s[38:39], 0
  s_mov_b32 s52, 0xba983210
  s_mov_b32 s53, 0xfedc7654
  s_lshl_b32 s54, s2, 2
  s_lshr_b64 s[52:53], s[52:53], s54
  s_and_b32 s54, s52, 15
  s_lshl_b32 s54, s54, 4
  s_add_u32 s54, s54, s6
  s_mov_b32 s1, s54
  s_lshl_b32 s7, s54, 18
  s_lshl_b32 s14, s3, 10
  s_add_u32 s7, s7, s14
  v_mov_b32 v5, 0x40000000
  s_mov_b32 exec_hi, 0
  v_mov_b32 v5, v3
  s_mov_b32 exec_hi, -1
  s_cmp_eq_u32 s3, 0
  s_cselect_b32 s100, s97, 0x40000000
  v_and_b32 v1, 15, v0
  v_lshrrev_b32 v13, 4, v0
  v_lshlrev_b32 v1, 6, v1
  v_lshl_add_u32 v1, v13, 4, v1
  s_mov_b32 s40, s18
  s_mov_b32 s41, s19
  s_mov_b32 s42, 0x4000000
  s_mov_b32 s43, 0x20000
  v_mov_b32 v7, 0
  v_lshlrev_b32 v88, 2, v0
  v_mov_b32 v89, 1
  s_barrier
  s_add_u32 s98, s97, 294912
  buffer_load_dwordx4 v[124:127], v5, s[48:51], s98 offen offset:0 nt
  buffer_load_dwordx4 v[128:131], v5, s[48:51], s98 offen offset:512 nt
  buffer_load_dwordx4 v[132:135], v3, s[48:51], s100 offen offset:1024 nt
  s_add_u32 s98, s100, 73728
  buffer_load_dwordx4 v[136:139], v3, s[48:51], s98 offen offset:1024 nt
  s_add_u32 s98, s100, 147456
  buffer_load_dwordx4 v[140:143], v3, s[48:51], s98 offen offset:1024 nt
  s_add_u32 s98, s100, 221184
  buffer_load_dwordx4 v[144:147], v3, s[48:51], s98 offen offset:1024 nt
  s_add_u32 s98, s100, 294912
  buffer_load_dwordx4 v[148:151], v5, s[48:51], s98 offen offset:1024 nt
  s_waitcnt vmcnt(11)
  buffer_load_dwordx4 v[152:155], v1, s[40:43], s7 offen nt
  ds_add_rtn_u32 v90, v88, v89 offset:2844
  s_and_b32 s5, s2, 7
  s_lshl_b32 s5, s5, 1
  s_bfe_u32 s14, s2, 0x10003
  s_add_u32 s5, s5, s14
  s_lshl_b32 s4, s5, 4
  s_add_u32 s4, s4, s6
  s_mov_b32 s44, s20
  s_mov_b32 s45, s21
  s_mov_b32 s46, 0x4000000
  s_mov_b32 s47, 0x20000
  s_mov_b32 s52, s24
  s_mov_b32 s53, s25
  s_mov_b32 s54, 0x480000
  s_mov_b32 s55, 0x20000
  s_mov_b32 s56, s32
  s_mov_b32 s57, s33
  s_mov_b32 s58, 0x510000
  s_mov_b32 s59, 0x20000
  s_mov_b32 s60, s38
  s_mov_b32 s61, s39
  s_mov_b32 s62, 0x10000000
  s_mov_b32 s63, 0x20000
  s_waitcnt vmcnt(11)
  s_addk_i32 s7, 8192
  buffer_load_dwordx4 v[156:159], v1, s[40:43], s7 offen nt
  s_waitcnt vmcnt(11)
  s_addk_i32 s7, -4096
  buffer_load_dwordx4 v[160:163], v1, s[40:43], s7 offen nt
  ds_add_rtn_u32 v90, v88, v89 offset:2844
  s_mov_b32 s9, 0x3fb8aa3b
  s_mov_b32 s10, 0x3db504f3
  s_mov_b32 s11, 0x01000100
  s_mov_b32 s12, 0x03020302
  s_mov_b32 s13, 0xffff0000
  v_lshlrev_b32 v2, 4, v0
  v_mov_b32 v8, 0xff61b1e6
  v_mov_b32 v9, 0
  v_mov_b32 v24, 0
  v_mov_b32 v25, 0
  v_mov_b32 v26, 0
  v_mov_b32 v27, 0
  v_bfe_u32 v14, v0, 3, 1
  v_lshlrev_b32 v14, 8, v14
  v_and_b32 v13, 3, v0
  v_lshl_add_u32 v14, v13, 6, v14
  v_lshrrev_b32 v13, 4, v0
  v_lshl_add_u32 v11, v13, 4, v14
  s_waitcnt vmcnt(11)
  s_addk_i32 s7, 8192
  buffer_load_dwordx4 v[164:167], v1, s[40:43], s7 offen nt
  s_waitcnt vmcnt(11)
  s_addk_i32 s7, 4096
  buffer_load_dwordx4 v[168:171], v1, s[40:43], s7 offen nt
  ds_add_rtn_u32 v90, v88, v89 offset:2844
  v_and_b32 v14, 1, v0
  v_lshlrev_b32 v14, 4, v14
  v_mov_b32 v13, 0xffff
  v_lshlrev_b32 v13, v14, v13
  v_mov_b32 v16, 0
  v_mov_b32 v17, 0
  v_mov_b32 v18, 0
  v_mov_b32 v19, 0
  s_mov_b32 exec_lo, 0x3030303
  s_mov_b32 exec_hi, 0x3030303
  v_mov_b32 v16, v13
  s_mov_b32 exec_lo, 0xc0c0c0c
  s_mov_b32 exec_hi, 0xc0c0c0c
  v_mov_b32 v17, v13
  s_mov_b32 exec_lo, 0x30303030
  s_mov_b32 exec_hi, 0x30303030
  v_mov_b32 v18, v13
  s_mov_b32 exec_lo, 0xc0c0c0c0
  s_mov_b32 exec_hi, 0xc0c0c0c0
  v_mov_b32 v19, v13
  s_mov_b64 exec, -1
  s_waitcnt vmcnt(4)
  s_addk_i32 s7, 8192
  buffer_load_dwordx4 v[172:175], v1, s[40:43], s7 offen nt
  s_waitcnt vmcnt(4)
  s_addk_i32 s7, -4096
  buffer_load_dwordx4 v[176:179], v1, s[40:43], s7 offen nt
  ds_add_rtn_u32 v90, v88, v89 offset:2844
  s_waitcnt vmcnt(4)
  s_addk_i32 s7, 8192
  buffer_load_dwordx4 v[180:183], v1, s[40:43], s7 offen nt
  s_waitcnt vmcnt(4)
  s_addk_i32 s7, 4096
  buffer_load_dwordx4 v[184:187], v1, s[40:43], s7 offen nt
  ds_add_rtn_u32 v90, v88, v89 offset:2844
  v_mul_u32_u24 v4, 1152, v15
  v_lshl_add_u32 v4, v12, 4, v4
  v_and_b32 v14, 8, v0
  v_lshrrev_b32 v13, 4, v0
  v_add_u32 v14, v14, v13
  v_mul_u32_u24 v3, 1152, v14
  v_lshl_add_u32 v3, v12, 4, v3
  v_mov_b32 v5, 0x40000000
  s_mov_b64 exec, 0xffff
  v_mov_b32 v5, v4
  s_mov_b64 exec, -1
  v_lshrrev_b32 v14, 2, v0
  v_mul_u32_u24 v36, 1216, v14
  v_add_u32 v36, v36, v2
  s_and_b32 s14, s4, 1
  s_lshl_b32 s14, s14, 1
  v_add_lshl_u32 v39, v15, s14, 2
  s_and_b32 s97, s1, 0xf8
  s_lshl_b32 s97, s97, 4
  s_and_b32 s14, s6, 3
  s_lshl_b32 s14, s14, 5
  s_add_u32 s97, s97, s14
  s_and_b32 s14, s6, 4
  s_add_u32 s97, s97, s14
  s_mul_i32 s97, s97, 1152
  s_lshl_b32 s14, s3, 7
  s_add_u32 s97, s97, s14
  s_mul_i32 s98, s4, 20736
  s_add_u32 s98, s98, s14
  s_cmp_eq_u32 s3, 0
  s_cselect_b32 s100, s97, 0x40000000
  s_cselect_b32 s101, s98, 0x40000000
  s_waitcnt vmcnt(4)
  s_addk_i32 s7, 8192
  buffer_load_dwordx4 v[188:191], v1, s[40:43], s7 offen nt
  s_waitcnt vmcnt(4)
  s_addk_i32 s7, -4096
  buffer_load_dwordx4 v[192:195], v1, s[40:43], s7 offen nt
  ds_add_rtn_u32 v90, v88, v89 offset:2844
  v_and_b32 v14, 16, v0
  v_lshl_add_u32 v14, v12, 5, v14
  v_lshrrev_b32 v13, 5, v0
  v_lshl_add_u32 v13, v13, 2, s3
  v_lshl_add_u32 v6, v13, 8, v14
  s_mov_b32 exec_lo, 0xff00ff00
  s_mov_b32 exec_hi, 0xff00ff00
  v_mov_b32 v6, 0x40000000
  s_cmp_eq_u32 s3, 0
  s_cselect_b32 s14, 2048, 0x40000000
  s_mov_b32 exec_hi, 0
  v_add_u32 v6, s14, v14
  s_mov_b64 exec, -1
  s_lshr_b32 s48, s2, 3
  s_mul_i32 s48, s48, 18432
  s_and_b32 s14, s2, 7
  s_mul_i32 s14, s14, 2304
  s_add_u32 s48, s48, s14
  s_add_u32 s48, s48, 524288
  s_waitcnt vmcnt(4)
  s_addk_i32 s7, 8192
  buffer_load_dwordx4 v[196:199], v1, s[40:43], s7 offen nt
  s_waitcnt vmcnt(4)
  s_addk_i32 s7, 4096
  buffer_load_dwordx4 v[200:203], v1, s[40:43], s7 offen nt
  ds_add_rtn_u32 v90, v88, v89 offset:2844
  s_waitcnt vmcnt(4)
  s_addk_i32 s7, 8192
  buffer_load_dwordx4 v[204:207], v1, s[40:43], s7 offen nt
  s_mul_i32 s14, s6, 144
  v_lshl_add_u32 v10, v15, 2, s14
  ds_read_b32 v91, v7 offset:2820
  ds_read_b32 v40, v10 offset:0
  ds_read_b32 v41, v10 offset:32
  ds_read_b32 v42, v10 offset:64
  ds_read_b32 v43, v10 offset:96
  ds_read_b32 v44, v10 offset:128
  s_waitcnt vmcnt(4)
  s_addk_i32 s7, -4096
  buffer_load_dwordx4 v[208:211], v1, s[40:43], s7 offen nt
  ds_add_rtn_u32 v90, v88, v89 offset:2844
  s_waitcnt lgkmcnt(0)
  v_readfirstlane_b32 s27, v91
  s_nop 0
  s_cmp_lt_u32 s27, 1
  s_cbranch_scc1 L_xw
L_xw_ok:
  s_mul_i32 s8, s8, 1664525
  s_add_u32 s8, s8, 1013904223
  s_mov_b32 exec_lo, 0
  v_mov_b32 v44, 0
  s_mov_b32 exec_lo, -1
  v_and_b32 v28, v16, v40
  v_and_b32 v29, v17, v40
  v_and_b32 v30, v18, v40
  v_and_b32 v31, v19, v40
  s_nop 1
  v_mfma_f32_16x16x32_bf16 v[56:59], v[28:31], v[92:95], 0
  v_mfma_f32_16x16x32_bf16 v[60:63], v[28:31], v[96:99], 0
  v_mfma_f32_16x16x32_bf16 v[64:67], v[28:31], v[132:135], 0
  s_waitcnt vmcnt(4)
  s_addk_i32 s7, 8192
  buffer_load_dwordx4 v[212:215], v1, s[40:43], s7 offen nt
  v_and_b32 v32, v16, v41
  v_and_b32 v33, v17, v41
  v_and_b32 v34, v18, v41
  v_and_b32 v35, v19, v41
  s_nop 1
  v_mfma_f32_16x16x32_bf16 v[56:59], v[32:35], v[100:103], v[56:59]
  v_mfma_f32_16x16x32_bf16 v[60:63], v[32:35], v[104:107], v[60:63]
  v_mfma_f32_16x16x32_bf16 v[64:67], v[32:35], v[136:139], v[64:67]
  s_waitcnt vmcnt(4)
  s_addk_i32 s7, 4096
  buffer_load_dwordx4 v[216:219], v1, s[40:43], s7 offen nt
  ds_add_rtn_u32 v90, v88, v89 offset:2844
  v_and_b32 v28, v16, v42
  v_and_b32 v29, v17, v42
  v_and_b32 v30, v18, v42
  v_and_b32 v31, v19, v42
  s_nop 1
  v_mfma_f32_16x16x32_bf16 v[56:59], v[28:31], v[108:111], v[56:59]
  v_mfma_f32_16x16x32_bf16 v[60:63], v[28:31], v[112:115], v[60:63]
  v_mfma_f32_16x16x32_bf16 v[64:67], v[28:31], v[140:143], v[64:67]
  s_waitcnt vmcnt(4)
  s_addk_i32 s7, 8192
  buffer_load_dwordx4 v[220:223], v1, s[40:43], s7 offen nt
  v_and_b32 v32, v16, v43
  v_and_b32 v33, v17, v43
  v_and_b32 v34, v18, v43
  v_and_b32 v35, v19, v43
  s_nop 1
  v_mfma_f32_16x16x32_bf16 v[56:59], v[32:35], v[116:119], v[56:59]
  v_mfma_f32_16x16x32_bf16 v[60:63], v[32:35], v[120:123], v[60:63]
  v_mfma_f32_16x16x32_bf16 v[64:67], v[32:35], v[144:147], v[64:67]
  s_waitcnt vmcnt(4)
  s_addk_i32 s7, -4096
  buffer_load_dwordx4 v[224:227], v1, s[40:43], s7 offen nt
  ds_add_rtn_u32 v90, v88, v89 offset:2844
  v_and_b32 v28, v16, v44
  v_and_b32 v29, v17, v44
  v_and_b32 v30, v18, v44
  v_and_b32 v31, v19, v44
  s_nop 1
  v_mfma_f32_16x16x32_bf16 v[56:59], v[28:31], v[124:127], v[56:59]
  v_mfma_f32_16x16x32_bf16 v[60:63], v[28:31], v[128:131], v[60:63]
  v_mfma_f32_16x16x32_bf16 v[64:67], v[28:31], v[148:151], v[64:67]
  s_waitcnt vmcnt(4)
  s_addk_i32 s7, 8192
  buffer_load_dwordx4 v[228:231], v1, s[40:43], s7 offen nt
  s_nop 4
  v_permlane32_swap_b32 v64, v40
  v_permlane32_swap_b32 v65, v41
  v_permlane32_swap_b32 v66, v42
  v_permlane32_swap_b32 v67, v43
  v_add_f32_dpp v40, v64, v40 row_ror:8 row_mask:0xf bank_mask:0xc
  v_add_f32_dpp v41, v65, v41 row_ror:8 row_mask:0xf bank_mask:0xc
  v_add_f32_dpp v42, v66, v42 row_ror:8 row_mask:0xf bank_mask:0xc
  v_add_f32_dpp v43, v67, v43 row_ror:8 row_mask:0xf bank_mask:0xc
  v_permlane32_swap_b32 v56, v60
  v_permlane32_swap_b32 v57, v61
  v_permlane32_swap_b32 v58, v62
  v_permlane32_swap_b32 v59, v63
  v_add_f32_dpp v40, v60, v56 row_ror:8 row_mask:0xf bank_mask:0x3
  v_add_f32_dpp v41, v61, v57 row_ror:8 row_mask:0xf bank_mask:0x3
  v_add_f32_dpp v42, v62, v58 row_ror:8 row_mask:0xf bank_mask:0x3
  v_add_f32_dpp v43, v63, v59 row_ror:8 row_mask:0xf bank_mask:0x3
  v_mov_b32_sdwa v40, s8 dst_sel:BYTE_0 dst_unused:UNUSED_PRESERVE src0_sel:BYTE_0
  v_mov_b32_sdwa v41, s8 dst_sel:BYTE_0 dst_unused:UNUSED_PRESERVE src0_sel:BYTE_1
  v_mov_b32_sdwa v42, s8 dst_sel:BYTE_0 dst_unused:UNUSED_PRESERVE src0_sel:BYTE_2
  v_mov_b32_sdwa v43, s8 dst_sel:BYTE_0 dst_unused:UNUSED_PRESERVE src0_sel:BYTE_3
  s_waitcnt vmcnt(4)
  s_addk_i32 s7, 4096
  buffer_load_dwordx4 v[232:235], v1, s[40:43], s7 offen nt
  ds_add_rtn_u32 v90, v88, v89 offset:2844
  v_cmp_gt_u32 vcc, 0x1000, v6
  s_not_b32 s49, s8
  s_mov_b64 exec, vcc
  ds_write_b128 v6, v[40:43] offset:4096
  s_mov_b64 exec, 1
  ds_add_u32 v7, v89 offset:2832
  s_mov_b64 exec, -1
  s_bfe_u32 s28, s49, 0x80000
  s_bfe_u32 s29, s49, 0x80008
  s_bfe_u32 s30, s49, 0x80010
  s_bfe_u32 s31, s49, 0x80018
  s_mov_b64 vcc, -1
  v_and_b32 v6, 0xffffff00, v6
  v_and_b32 v14, 16, v0
  v_lshl_add_u32 v6, v14, 3, v6
  v_lshl_add_u32 v6, v12, 4, v6
  s_waitcnt vmcnt(4)
  s_addk_i32 s7, 8192
  buffer_load_dwordx4 v[236:239], v1, s[40:43], s7 offen nt
  s_waitcnt vmcnt(4)
  s_cbranch_vccz L_w37
  s_waitcnt vmcnt(4)
L_w37:
  s_addk_i32 s7, -4096
  buffer_load_dwordx4 v[240:243], v1, s[40:43], s7 offen nt
  ds_add_rtn_u32 v90, v88, v89 offset:2844
  s_waitcnt lgkmcnt(0)
  v_readfirstlane_b32 s27, v90
  s_nop 0
  s_lshr_b64 vcc, s[26:27], 63
  s_cbranch_vccz L_w38
  s_waitcnt vmcnt(4)
L_w38:
  s_addk_i32 s7, 8192
  buffer_load_dwordx4 v[244:247], v1, s[40:43], s7 offen nt
  s_waitcnt vmcnt(5)
  s_cbranch_vccz L_w39
  s_waitcnt vmcnt(4)
L_w39:
  s_addk_i32 s7, 4096
  buffer_load_dwordx4 v[248:251], v1, s[40:43], s7 offen nt
  ds_add_rtn_u32 v90, v88, v89 offset:2844
  s_waitcnt vmcnt(5)
  s_waitcnt lgkmcnt(0)
  v_readfirstlane_b32 s27, v90
  s_nop 0
  s_lshr_b64 vcc, s[26:27], 63
  s_cbranch_vccz L_w40
  s_waitcnt vmcnt(4)
L_w40:
  s_addk_i32 s7, 8192
  buffer_load_dwordx4 v[92:95], v1, s[40:43], s7 offen nt
  s_waitcnt vmcnt(5)
  s_cbranch_vccz L_w41
  s_waitcnt vmcnt(4)
L_w41:
  s_addk_i32 s7, -4096
  buffer_load_dwordx4 v[96:99], v1, s[40:43], s7 offen nt
  ds_add_rtn_u32 v90, v88, v89 offset:2844
  s_waitcnt vmcnt(5)
  s_waitcnt lgkmcnt(0)
  v_readfirstlane_b32 s27, v90
  s_nop 0
  s_lshr_b64 vcc, s[26:27], 63
  s_cbranch_vccz L_w42
  s_waitcnt vmcnt(4)
L_w42:
  s_addk_i32 s7, 8192
  buffer_load_dwordx4 v[132:135], v1, s[40:43], s7 offen nt
  s_waitcnt vmcnt(5)
  s_cbranch_vccz L_w43
  s_waitcnt vmcnt(4)
L_w43:
  s_addk_i32 s7, 4096
  buffer_load_dwordx4 v[100:103], v1, s[40:43], s7 offen nt
  ds_add_rtn_u32 v90, v88, v89 offset:2844
  s_waitcnt vmcnt(5)
  s_waitcnt lgkmcnt(0)
  v_readfirstlane_b32 s27, v90
  s_nop 0
  s_lshr_b64 vcc, s[26:27], 63
  s_cbranch_vccz L_w44
  s_waitcnt vmcnt(4)
L_w44:
  s_addk_i32 s7, 8192
  buffer_load_dwordx4 v[104:107], v1, s[40:43], s7 offen nt
  s_waitcnt vmcnt(5)
  s_cbranch_vccz L_w45
  s_waitcnt vmcnt(4)
L_w45:
  s_addk_i32 s7, -4096
  buffer_load_dwordx4 v[136:139], v1, s[40:43], s7 offen nt
  ds_add_rtn_u32 v90, v88, v89 offset:2844
  s_waitcnt vmcnt(5)
  s_waitcnt lgkmcnt(0)
  v_readfirstlane_b32 s27, v90
  s_nop 0
  s_lshr_b64 vcc, s[26:27], 63
  s_cbranch_vccz L_w46
  s_waitcnt vmcnt(4)
L_w46:
  s_addk_i32 s7, 8192
  buffer_load_dwordx4 v[108:111], v1, s[40:43], s7 offen nt
  s_waitcnt vmcnt(5)
  s_cbranch_vccz L_w47
  s_waitcnt vmcnt(4)
L_w47:
  s_addk_i32 s7, 4096
  buffer_load_dwordx4 v[112:115], v1, s[40:43], s7 offen nt
  ds_add_rtn_u32 v90, v88, v89 offset:2844
  s_waitcnt vmcnt(5)
  s_waitcnt lgkmcnt(0)
  v_readfirstlane_b32 s27, v90
  s_nop 0
  s_lshr_b64 vcc, s[26:27], 63
  s_cbranch_vccz L_w48
  s_waitcnt vmcnt(4)
L_w48:
  s_addk_i32 s7, 8192
  buffer_load_dwordx4 v[140:143], v1, s[40:43], s7 offen nt
  s_waitcnt vmcnt(5)
  s_cbranch_vccz L_w49
  s_waitcnt vmcnt(4)
L_w49:
  s_addk_i32 s7, -4096
  buffer_load_dwordx4 v[116:119], v1, s[40:43], s7 offen nt
  ds_add_rtn_u32 v90, v88, v89 offset:2844
  s_waitcnt vmcnt(5)
  s_waitcnt lgkmcnt(0)
  v_readfirstlane_b32 s27, v90
  s_nop 0
  s_lshr_b64 vcc, s[26:27], 63
  s_cbranch_vccz L_w50
  s_waitcnt vmcnt(4)
L_w50:
  s_addk_i32 s7, 8192
  buffer_load_dwordx4 v[120:123], v1, s[40:43], s7 offen nt
  s_waitcnt vmcnt(5)
  s_cbranch_vccz L_w51
  s_waitcnt vmcnt(4)
L_w51:
  s_addk_i32 s7, 4096
  buffer_load_dwordx4 v[144:147], v1, s[40:43], s7 offen nt
  ds_add_rtn_u32 v90, v88, v89 offset:2844
  s_waitcnt vmcnt(5)
  s_waitcnt lgkmcnt(0)
  v_readfirstlane_b32 s27, v90
  s_nop 0
  s_lshr_b64 vcc, s[26:27], 63
  s_cbranch_vccz L_w52
  s_waitcnt vmcnt(4)
L_w52:
  s_addk_i32 s7, 8192
  buffer_load_dwordx4 v[124:127], v1, s[40:43], s7 offen nt
  s_waitcnt vmcnt(5)
  s_cbranch_vccz L_w53
  s_waitcnt vmcnt(4)
L_w53:
  s_addk_i32 s7, -4096
  buffer_load_dwordx4 v[128:131], v1, s[40:43], s7 offen nt
  ds_add_rtn_u32 v90, v88, v89 offset:2844
  ds_read_b32 v91, v7 offset:2820
  ds_read_b128 v[20:23], v11 offset:2304
  s_waitcnt vmcnt(5)
  s_waitcnt lgkmcnt(0)
  v_readfirstlane_b32 s27, v90
  s_nop 0
  s_lshr_b64 vcc, s[26:27], 63
  s_cbranch_vccz L_w54
  s_waitcnt vmcnt(4)
L_w54:
  s_addk_i32 s7, 8192
  buffer_load_dwordx4 v[148:151], v1, s[40:43], s7 offen nt
  s_waitcnt lgkmcnt(0)
  v_readfirstlane_b32 s27, v91
  s_nop 0
  s_cmp_lt_u32 s27, 2
  s_cbranch_scc1 L_qw
L_qw_ok:
  s_and_b32 s99, s27, 1
  v_mfma_f32_16x16x32_bf16 v[40:43], v[152:155], v[20:23], 0
  v_mfma_f32_16x16x32_bf16 v[44:47], v[156:159], v[20:23], 0
  s_waitcnt vmcnt(5)
  s_cbranch_vccz L_w55
  s_waitcnt vmcnt(4)
L_w55:
  s_addk_i32 s7, 4096
  buffer_load_dwordx4 v[152:155], v1, s[40:43], s7 offen nt
  ds_add_rtn_u32 v90, v88, v89 offset:2844
  s_nop 1
  v_mov_b32_dpp v12, v40 quad_perm:[0,0,0,0] row_mask:0xf bank_mask:0xf
  v_mov_b32_dpp v13, v44 quad_perm:[0,0,0,0] row_mask:0xf bank_mask:0xf
  v_mfma_f32_16x16x32_bf16 v[48:51], v[160:163], v[20:23], 0
  v_add_f32_dpp v12, v41, v12 quad_perm:[1,1,1,1] row_mask:0xf bank_mask:0xf
  v_add_f32_dpp v13, v45, v13 quad_perm:[1,1,1,1] row_mask:0xf bank_mask:0xf
  v_mfma_f32_16x16x32_bf16 v[52:55], v[164:167], v[20:23], 0
  v_add_f32_dpp v12, v42, v12 quad_perm:[2,2,2,2] row_mask:0xf bank_mask:0xf
  v_add_f32_dpp v13, v46, v13 quad_perm:[2,2,2,2] row_mask:0xf bank_mask:0xf
  s_nop 0
  v_add_f32_dpp v12, v43, v12 quad_perm:[3,3,3,3] row_mask:0xf bank_mask:0xf
  v_add_f32_dpp v13, v47, v13 quad_perm:[3,3,3,3] row_mask:0xf bank_mask:0xf
  v_max3_f32 v8, v12, v13, v8
  v_cvt_pk_bf16_f32 v14, v12, v13
  v_lshlrev_b32 v12, 16, v14
  v_and_b32 v13, s13, v14
  v_mul_f32 v12, s10, v12
  v_mul_f32 v13, s10, v13
  v_cvt_pk_bf16_f32 v56, v12, v13
  s_waitcnt vmcnt(5)
  s_waitcnt lgkmcnt(0)
  v_readfirstlane_b32 s27, v90
  s_nop 0
  s_lshr_b64 vcc, s[26:27], 63
  s_cbranch_vccz L_w56
  s_waitcnt vmcnt(4)
L_w56:
  s_addk_i32 s7, 8192
  buffer_load_dwordx4 v[156:159], v1, s[40:43], s7 offen nt
  v_mov_b32_dpp v12, v48 quad_perm:[0,0,0,0] row_mask:0xf bank_mask:0xf
  v_mov_b32_dpp v13, v52 quad_perm:[0,0,0,0] row_mask:0xf bank_mask:0xf
  v_mfma_f32_16x16x32_bf16 v[40:43], v[168:171], v[20:23], 0
  v_add_f32_dpp v12, v49, v12 quad_perm:[1,1,1,1] row_mask:0xf bank_mask:0xf
  v_add_f32_dpp v13, v53, v13 quad_perm:[1,1,1,1] row_mask:0xf bank_mask:0xf
  v_mfma_f32_16x16x32_bf16 v[44:47], v[172:175], v[20:23], 0
  v_add_f32_dpp v12, v50, v12 quad_perm:[2,2,2,2] row_mask:0xf bank_mask:0xf
  v_add_f32_dpp v13, v54, v13 quad_perm:[2,2,2,2] row_mask:0xf bank_mask:0xf
  s_nop 0
  v_add_f32_dpp v12, v51, v12 quad_perm:[3,3,3,3] row_mask:0xf bank_mask:0xf
  v_add_f32_dpp v13, v55, v13 quad_perm:[3,3,3,3] row_mask:0xf bank_mask:0xf
  v_max3_f32 v8, v12, v13, v8
  v_cvt_pk_bf16_f32 v14, v12, v13
  v_lshlrev_b32 v12, 16, v14
  v_and_b32 v13, s13, v14
  v_mul_f32 v12, s10, v12
  v_mul_f32 v13, s10, v13
  v_cvt_pk_bf16_f32 v57, v12, v13
  s_waitcnt vmcnt(5)
  s_cbranch_vccz L_w57
  s_waitcnt vmcnt(4)
L_w57:
  s_addk_i32 s7, -4096
  buffer_load_dwordx4 v[160:163], v1, s[40:43], s7 offen nt
  ds_add_rtn_u32 v90, v88, v89 offset:2844
  v_mov_b32_dpp v12, v40 quad_perm:[0,0,0,0] row_mask:0xf bank_mask:0xf
  v_mov_b32_dpp v13, v44 quad_perm:[0,0,0,0] row_mask:0xf bank_mask:0xf
  v_mfma_f32_16x16x32_bf16 v[48:51], v[176:179], v[20:23], 0
  v_add_f32_dpp v12, v41, v12 quad_perm:[1,1,1,1] row_mask:0xf bank_mask:0xf
  v_add_f32_dpp v13, v45, v13 quad_perm:[1,1,1,1] row_mask:0xf bank_mask:0xf
  v_mfma_f32_16x16x32_bf16 v[52:55], v[180:183], v[20:23], 0
  v_add_f32_dpp v12, v42, v12 quad_perm:[2,2,2,2] row_mask:0xf bank_mask:0xf
  v_add_f32_dpp v13, v46, v13 quad_perm:[2,2,2,2] row_mask:0xf bank_mask:0xf
  s_nop 0
  v_add_f32_dpp v12, v43, v12 quad_perm:[3,3,3,3] row_mask:0xf bank_mask:0xf
  v_add_f32_dpp v13, v47, v13 quad_perm:[3,3,3,3] row_mask:0xf bank_mask:0xf
  v_max3_f32 v8, v12, v13, v8
  v_cvt_pk_bf16_f32 v14, v12, v13
  v_lshlrev_b32 v12, 16, v14
  v_and_b32 v13, s13, v14
  v_mul_f32 v12, s10, v12
  v_mul_f32 v13, s10, v13
  v_cvt_pk_bf16_f32 v58, v12, v13
  s_waitcnt vmcnt(5)
  s_waitcnt lgkmcnt(0)
  v_readfirstlane_b32 s27, v90
  s_nop 0
  s_lshr_b64 vcc, s[26:27], 63
  s_cbranch_vccz L_w58
  s_waitcnt vmcnt(4)
L_w58:
  s_addk_i32 s7, 8192
  buffer_load_dwordx4 v[164:167], v1, s[40:43], s7 offen nt
  v_mov_b32_dpp v12, v48 quad_perm:[0,0,0,0] row_mask:0xf bank_mask:0xf
  v_mov_b32_dpp v13, v52 quad_perm:[0,0,0,0] row_mask:0xf bank_mask:0xf
  v_mfma_f32_16x16x32_bf16 v[40:43], v[184:187], v[20:23], 0
  v_add_f32_dpp v12, v49, v12 quad_perm:[1,1,1,1] row_mask:0xf bank_mask:0xf
  v_add_f32_dpp v13, v53, v13 quad_perm:[1,1,1,1] row_mask:0xf bank_mask:0xf
  v_mfma_f32_16x16x32_bf16 v[44:47], v[188:191], v[20:23], 0
  v_add_f32_dpp v12, v50, v12 quad_perm:[2,2,2,2] row_mask:0xf bank_mask:0xf
  v_add_f32_dpp v13, v54, v13 quad_perm:[2,2,2,2] row_mask:0xf bank_mask:0xf
  s_nop 0
  v_add_f32_dpp v12, v51, v12 quad_perm:[3,3,3,3] row_mask:0xf bank_mask:0xf
  v_add_f32_dpp v13, v55, v13 quad_perm:[3,3,3,3] row_mask:0xf bank_mask:0xf
  v_max3_f32 v8, v12, v13, v8
  v_cvt_pk_bf16_f32 v14, v12, v13
  v_lshlrev_b32 v12, 16, v14
  v_and_b32 v13, s13, v14
  v_mul_f32 v12, s10, v12
  v_mul_f32 v13, s10, v13
  v_cvt_pk_bf16_f32 v59, v12, v13
  s_waitcnt vmcnt(5)
  s_cbranch_vccz L_w59
  s_waitcnt vmcnt(4)
L_w59:
  s_addk_i32 s7, 4096
  buffer_load_dwordx4 v[168:171], v1, s[40:43], s7 offen nt
  ds_add_rtn_u32 v90, v88, v89 offset:2844
  v_mov_b32_dpp v12, v40 quad_perm:[0,0,0,0] row_mask:0xf bank_mask:0xf
  v_mov_b32_dpp v13, v44 quad_perm:[0,0,0,0] row_mask:0xf bank_mask:0xf
  v_mfma_f32_16x16x32_bf16 v[48:51], v[192:195], v[20:23], 0
  v_add_f32_dpp v12, v41, v12 quad_perm:[1,1,1,1] row_mask:0xf bank_mask:0xf
  v_add_f32_dpp v13, v45, v13 quad_perm:[1,1,1,1] row_mask:0xf bank_mask:0xf
  v_mfma_f32_16x16x32_bf16 v[52:55], v[196:199], v[20:23], 0
  v_add_f32_dpp v12, v42, v12 quad_perm:[2,2,2,2] row_mask:0xf bank_mask:0xf
  v_add_f32_dpp v13, v46, v13 quad_perm:[2,2,2,2] row_mask:0xf bank_mask:0xf
  s_nop 0
  v_add_f32_dpp v12, v43, v12 quad_perm:[3,3,3,3] row_mask:0xf bank_mask:0xf
  v_add_f32_dpp v13, v47, v13 quad_perm:[3,3,3,3] row_mask:0xf bank_mask:0xf
  v_max3_f32 v8, v12, v13, v8
  v_cvt_pk_bf16_f32 v14, v12, v13
  v_lshlrev_b32 v12, 16, v14
  v_and_b32 v13, s13, v14
  v_mul_f32 v12, s10, v12
  v_mul_f32 v13, s10, v13
  v_cvt_pk_bf16_f32 v60, v12, v13
  s_waitcnt vmcnt(5)
  s_waitcnt lgkmcnt(0)
  v_readfirstlane_b32 s27, v90
  s_nop 0
  s_lshr_b64 vcc, s[26:27], 63
  s_cbranch_vccz L_w60
  s_waitcnt vmcnt(4)
L_w60:
  s_addk_i32 s7, 8192
  buffer_load_dwordx4 v[172:175], v1, s[40:43], s7 offen nt
  v_mov_b32_dpp v12, v48 quad_perm:[0,0,0,0] row_mask:0xf bank_mask:0xf
  v_mov_b32_dpp v13, v52 quad_perm:[0,0,0,0] row_mask:0xf bank_mask:0xf
  v_mfma_f32_16x16x32_bf16 v[40:43], v[200:203], v[20:23], 0
  v_add_f32_dpp v12, v49, v12 quad_perm:[1,1,1,1] row_mask:0xf bank_mask:0xf
  v_add_f32_dpp v13, v53, v13 quad_perm:[1,1,1,1] row_mask:0xf bank_mask:0xf
  v_mfma_f32_16x16x32_bf16 v[44:47], v[204:207], v[20:23], 0
  v_add_f32_dpp v12, v50, v12 quad_perm:[2,2,2,2] row_mask:0xf bank_mask:0xf
  v_add_f32_dpp v13, v54, v13 quad_perm:[2,2,2,2] row_mask:0xf bank_mask:0xf
  s_nop 0
  v_add_f32_dpp v12, v51, v12 quad_perm:[3,3,3,3] row_mask:0xf bank_mask:0xf
  v_add_f32_dpp v13, v55, v13 quad_perm:[3,3,3,3] row_mask:0xf bank_mask:0xf
  v_max3_f32 v8, v12, v13, v8
  v_cvt_pk_bf16_f32 v14, v12, v13
  v_lshlrev_b32 v12, 16, v14
  v_and_b32 v13, s13, v14
  v_mul_f32 v12, s10, v12
  v_mul_f32 v13, s10, v13
  v_cvt_pk_bf16_f32 v61, v12, v13
  s_waitcnt vmcnt(5)
  s_cbranch_vccz L_w61
  s_waitcnt vmcnt(4)
L_w61:
  s_addk_i32 s7, -4096
  buffer_load_dwordx4 v[176:179], v1, s[40:43], s7 offen nt
  ds_add_rtn_u32 v90, v88, v89 offset:2844
  v_mov_b32_dpp v12, v40 quad_perm:[0,0,0,0] row_mask:0xf bank_mask:0xf
  v_mov_b32_dpp v13, v44 quad_perm:[0,0,0,0] row_mask:0xf bank_mask:0xf
  v_mfma_f32_16x16x32_bf16 v[48:51], v[208:211], v[20:23], 0
  v_add_f32_dpp v12, v41, v12 quad_perm:[1,1,1,1] row_mask:0xf bank_mask:0xf
  v_add_f32_dpp v13, v45, v13 quad_perm:[1,1,1,1] row_mask:0xf bank_mask:0xf
  v_mfma_f32_16x16x32_bf16 v[52:55], v[212:215], v[20:23], 0
  v_add_f32_dpp v12, v42, v12 quad_perm:[2,2,2,2] row_mask:0xf bank_mask:0xf
  v_add_f32_dpp v13, v46, v13 quad_perm:[2,2,2,2] row_mask:0xf bank_mask:0xf
  s_nop 0
  v_add_f32_dpp v12, v43, v12 quad_perm:[3,3,3,3] row_mask:0xf bank_mask:0xf
  v_add_f32_dpp v13, v47, v13 quad_perm:[3,3,3,3] row_mask:0xf bank_mask:0xf
  v_max3_f32 v8, v12, v13, v8
  v_cvt_pk_bf16_f32 v14, v12, v13
  v_lshlrev_b32 v12, 16, v14
  v_and_b32 v13, s13, v14
  v_mul_f32 v12, s10, v12
  v_mul_f32 v13, s10, v13
  v_cvt_pk_bf16_f32 v62, v12, v13
  s_waitcnt vmcnt(5)
  s_waitcnt lgkmcnt(0)
  v_readfirstlane_b32 s27, v90
  s_nop 0
  s_lshr_b64 vcc, s[26:27], 63
  s_cbranch_vccz L_w62
  s_waitcnt vmcnt(4)
L_w62:
  s_addk_i32 s7, 8192
  buffer_load_dwordx4 v[180:183], v1, s[40:43], s7 offen nt
  v_mov_b32_dpp v12, v48 quad_perm:[0,0,0,0] row_mask:0xf bank_mask:0xf
  v_mov_b32_dpp v13, v52 quad_perm:[0,0,0,0] row_mask:0xf bank_mask:0xf
  v_mfma_f32_16x16x32_bf16 v[40:43], v[216:219], v[20:23], 0
  v_add_f32_dpp v12, v49, v12 quad_perm:[1,1,1,1] row_mask:0xf bank_mask:0xf
  v_add_f32_dpp v13, v53, v13 quad_perm:[1,1,1,1] row_mask:0xf bank_mask:0xf
  v_mfma_f32_16x16x32_bf16 v[44:47], v[220:223], v[20:23], 0
  v_add_f32_dpp v12, v50, v12 quad_perm:[2,2,2,2] row_mask:0xf bank_mask:0xf
  v_add_f32_dpp v13, v54, v13 quad_perm:[2,2,2,2] row_mask:0xf bank_mask:0xf
  s_nop 0
  v_add_f32_dpp v12, v51, v12 quad_perm:[3,3,3,3] row_mask:0xf bank_mask:0xf
  v_add_f32_dpp v13, v55, v13 quad_perm:[3,3,3,3] row_mask:0xf bank_mask:0xf
  v_max3_f32 v8, v12, v13, v8
  v_cvt_pk_bf16_f32 v14, v12, v13
  v_lshlrev_b32 v12, 16, v14
  v_and_b32 v13, s13, v14
  v_mul_f32 v12, s10, v12
  v_mul_f32 v13, s10, v13
  v_cvt_pk_bf16_f32 v63, v12, v13
  s_waitcnt vmcnt(5)
  s_cbranch_vccz L_w63
  s_waitcnt vmcnt(4)
L_w63:
  s_addk_i32 s7, 4096
  buffer_load_dwordx4 v[184:187], v1, s[40:43], s7 offen nt
  ds_add_rtn_u32 v90, v88, v89 offset:2844
  v_mov_b32_dpp v12, v40 quad_perm:[0,0,0,0] row_mask:0xf bank_mask:0xf
  v_mov_b32_dpp v13, v44 quad_perm:[0,0,0,0] row_mask:0xf bank_mask:0xf
  v_mfma_f32_16x16x32_bf16 v[48:51], v[224:227], v[20:23], 0
  v_add_f32_dpp v12, v41, v12 quad_perm:[1,1,1,1] row_mask:0xf bank_mask:0xf
  v_add_f32_dpp v13, v45, v13 quad_perm:[1,1,1,1] row_mask:0xf bank_mask:0xf
  v_mfma_f32_16x16x32_bf16 v[52:55], v[228:231], v[20:23], 0
  v_add_f32_dpp v12, v42, v12 quad_perm:[2,2,2,2] row_mask:0xf bank_mask:0xf
  v_add_f32_dpp v13, v46, v13 quad_perm:[2,2,2,2] row_mask:0xf bank_mask:0xf
  s_nop 0
  v_add_f32_dpp v12, v43, v12 quad_perm:[3,3,3,3] row_mask:0xf bank_mask:0xf
  v_add_f32_dpp v13, v47, v13 quad_perm:[3,3,3,3] row_mask:0xf bank_mask:0xf
  v_max3_f32 v8, v12, v13, v8
  v_cvt_pk_bf16_f32 v14, v12, v13
  v_lshlrev_b32 v12, 16, v14
  v_and_b32 v13, s13, v14
  v_mul_f32 v12, s10, v12
  v_mul_f32 v13, s10, v13
  v_cvt_pk_bf16_f32 v64, v12, v13
  s_waitcnt vmcnt(5)
  s_waitcnt lgkmcnt(0)
  v_readfirstlane_b32 s27, v90
  s_nop 0
  s_lshr_b64 vcc, s[26:27], 63
  s_cbranch_vccz L_w64
  s_waitcnt vmcnt(4)
L_w64:
  s_addk_i32 s7, 8192
  buffer_load_dwordx4 v[188:191], v1, s[40:43], s7 offen nt
  v_mov_b32_dpp v12, v48 quad_perm:[0,0,0,0] row_mask:0xf bank_mask:0xf
  v_mov_b32_dpp v13, v52 quad_perm:[0,0,0,0] row_mask:0xf bank_mask:0xf
  v_mfma_f32_16x16x32_bf16 v[40:43], v[232:235], v[20:23], 0
  v_add_f32_dpp v12, v49, v12 quad_perm:[1,1,1,1] row_mask:0xf bank_mask:0xf
  v_add_f32_dpp v13, v53, v13 quad_perm:[1,1,1,1] row_mask:0xf bank_mask:0xf
  v_mfma_f32_16x16x32_bf16 v[44:47], v[236:239], v[20:23], 0
  v_add_f32_dpp v12, v50, v12 quad_perm:[2,2,2,2] row_mask:0xf bank_mask:0xf
  v_add_f32_dpp v13, v54, v13 quad_perm:[2,2,2,2] row_mask:0xf bank_mask:0xf
  s_nop 0
  v_add_f32_dpp v12, v51, v12 quad_perm:[3,3,3,3] row_mask:0xf bank_mask:0xf
  v_add_f32_dpp v13, v55, v13 quad_perm:[3,3,3,3] row_mask:0xf bank_mask:0xf
  v_max3_f32 v8, v12, v13, v8
  v_cvt_pk_bf16_f32 v14, v12, v13
  v_lshlrev_b32 v12, 16, v14
  v_and_b32 v13, s13, v14
  v_mul_f32 v12, s10, v12
  v_mul_f32 v13, s10, v13
  v_cvt_pk_bf16_f32 v65, v12, v13
  s_waitcnt vmcnt(5)
  s_cbranch_vccz L_w65
  s_waitcnt vmcnt(4)
L_w65:
  s_addk_i32 s7, -4096
  buffer_load_dwordx4 v[192:195], v1, s[40:43], s7 offen nt
  ds_add_rtn_u32 v90, v88, v89 offset:2844
  v_mov_b32_dpp v12, v40 quad_perm:[0,0,0,0] row_mask:0xf bank_mask:0xf
  v_mov_b32_dpp v13, v44 quad_perm:[0,0,0,0] row_mask:0xf bank_mask:0xf
  v_mfma_f32_16x16x32_bf16 v[48:51], v[240:243], v[20:23], 0
  v_add_f32_dpp v12, v41, v12 quad_perm:[1,1,1,1] row_mask:0xf bank_mask:0xf
  v_add_f32_dpp v13, v45, v13 quad_perm:[1,1,1,1] row_mask:0xf bank_mask:0xf
  v_mfma_f32_16x16x32_bf16 v[52:55], v[244:247], v[20:23], 0
  v_add_f32_dpp v12, v42, v12 quad_perm:[2,2,2,2] row_mask:0xf bank_mask:0xf
  v_add_f32_dpp v13, v46, v13 quad_perm:[2,2,2,2] row_mask:0xf bank_mask:0xf
  s_nop 0
  v_add_f32_dpp v12, v43, v12 quad_perm:[3,3,3,3] row_mask:0xf bank_mask:0xf
  v_add_f32_dpp v13, v47, v13 quad_perm:[3,3,3,3] row_mask:0xf bank_mask:0xf
  v_max3_f32 v8, v12, v13, v8
  v_cvt_pk_bf16_f32 v14, v12, v13
  v_lshlrev_b32 v12, 16, v14
  v_and_b32 v13, s13, v14
  v_mul_f32 v12, s10, v12
  v_mul_f32 v13, s10, v13
  v_cvt_pk_bf16_f32 v66, v12, v13
  s_waitcnt vmcnt(5)
  s_waitcnt lgkmcnt(0)
  v_readfirstlane_b32 s27, v90
  s_nop 0
  s_lshr_b64 vcc, s[26:27], 63
  s_cbranch_vccz L_w66
  s_waitcnt vmcnt(4)
L_w66:
  s_addk_i32 s7, 8192
  buffer_load_dwordx4 v[196:199], v1, s[40:43], s7 offen nt
  v_mov_b32_dpp v12, v48 quad_perm:[0,0,0,0] row_mask:0xf bank_mask:0xf
  v_mov_b32_dpp v13, v52 quad_perm:[0,0,0,0] row_mask:0xf bank_mask:0xf
  v_mfma_f32_16x16x32_bf16 v[40:43], v[248:251], v[20:23], 0
  v_add_f32_dpp v12, v49, v12 quad_perm:[1,1,1,1] row_mask:0xf bank_mask:0xf
  v_add_f32_dpp v13, v53, v13 quad_perm:[1,1,1,1] row_mask:0xf bank_mask:0xf
  v_mfma_f32_16x16x32_bf16 v[44:47], v[92:95], v[20:23], 0
  v_add_f32_dpp v12, v50, v12 quad_perm:[2,2,2,2] row_mask:0xf bank_mask:0xf
  v_add_f32_dpp v13, v54, v13 quad_perm:[2,2,2,2] row_mask:0xf bank_mask:0xf
  s_nop 0
  v_add_f32_dpp v12, v51, v12 quad_perm:[3,3,3,3] row_mask:0xf bank_mask:0xf
  v_add_f32_dpp v13, v55, v13 quad_perm:[3,3,3,3] row_mask:0xf bank_mask:0xf
  v_max3_f32 v8, v12, v13, v8
  v_cvt_pk_bf16_f32 v14, v12, v13
  v_lshlrev_b32 v12, 16, v14
  v_and_b32 v13, s13, v14
  v_mul_f32 v12, s10, v12
  v_mul_f32 v13, s10, v13
  v_cvt_pk_bf16_f32 v67, v12, v13
  s_waitcnt vmcnt(5)
  s_cbranch_vccz L_w67
  s_waitcnt vmcnt(4)
L_w67:
  s_addk_i32 s7, 4096
  buffer_load_dwordx4 v[200:203], v1, s[40:43], s7 offen nt
  ds_add_rtn_u32 v90, v88, v89 offset:2844
  v_mov_b32_dpp v12, v40 quad_perm:[0,0,0,0] row_mask:0xf bank_mask:0xf
  v_mov_b32_dpp v13, v44 quad_perm:[0,0,0,0] row_mask:0xf bank_mask:0xf
  v_mfma_f32_16x16x32_bf16 v[48:51], v[96:99], v[20:23], 0
  v_add_f32_dpp v12, v41, v12 quad_perm:[1,1,1,1] row_mask:0xf bank_mask:0xf
  v_add_f32_dpp v13, v45, v13 quad_perm:[1,1,1,1] row_mask:0xf bank_mask:0xf
  v_mfma_f32_16x16x32_bf16 v[52:55], v[132:135], v[20:23], 0
  v_add_f32_dpp v12, v42, v12 quad_perm:[2,2,2,2] row_mask:0xf bank_mask:0xf
  v_add_f32_dpp v13, v46, v13 quad_perm:[2,2,2,2] row_mask:0xf bank_mask:0xf
  s_nop 0
  v_add_f32_dpp v12, v43, v12 quad_perm:[3,3,3,3] row_mask:0xf bank_mask:0xf
  v_add_f32_dpp v13, v47, v13 quad_perm:[3,3,3,3] row_mask:0xf bank_mask:0xf
  v_max3_f32 v8, v12, v13, v8
  v_cvt_pk_bf16_f32 v14, v12, v13
  v_lshlrev_b32 v12, 16, v14
  v_and_b32 v13, s13, v14
  v_mul_f32 v12, s10, v12
  v_mul_f32 v13, s10, v13
  v_cvt_pk_bf16_f32 v68, v12, v13
  s_waitcnt vmcnt(5)
  s_waitcnt lgkmcnt(0)
  v_readfirstlane_b32 s27, v90
  s_nop 0
  s_lshr_b64 vcc, s[26:27], 63
  s_cbranch_vccz L_w68
  s_waitcnt vmcnt(4)
L_w68:
  s_addk_i32 s7, 8192
  buffer_load_dwordx4 v[204:207], v1, s[40:43], s7 offen nt
  v_mov_b32_dpp v12, v48 quad_perm:[0,0,0,0] row_mask:0xf bank_mask:0xf
  v_mov_b32_dpp v13, v52 quad_perm:[0,0,0,0] row_mask:0xf bank_mask:0xf
  v_mfma_f32_16x16x32_bf16 v[40:43], v[100:103], v[20:23], 0
  v_add_f32_dpp v12, v49, v12 quad_perm:[1,1,1,1] row_mask:0xf bank_mask:0xf
  v_add_f32_dpp v13, v53, v13 quad_perm:[1,1,1,1] row_mask:0xf bank_mask:0xf
  v_mfma_f32_16x16x32_bf16 v[44:47], v[104:107], v[20:23], 0
  v_add_f32_dpp v12, v50, v12 quad_perm:[2,2,2,2] row_mask:0xf bank_mask:0xf
  v_add_f32_dpp v13, v54, v13 quad_perm:[2,2,2,2] row_mask:0xf bank_mask:0xf
  s_nop 0
  v_add_f32_dpp v12, v51, v12 quad_perm:[3,3,3,3] row_mask:0xf bank_mask:0xf
  v_add_f32_dpp v13, v55, v13 quad_perm:[3,3,3,3] row_mask:0xf bank_mask:0xf
  v_max3_f32 v8, v12, v13, v8
  v_cvt_pk_bf16_f32 v14, v12, v13
  v_lshlrev_b32 v12, 16, v14
  v_and_b32 v13, s13, v14
  v_mul_f32 v12, s10, v12
  v_mul_f32 v13, s10, v13
  v_cvt_pk_bf16_f32 v69, v12, v13
  s_waitcnt vmcnt(5)
  s_cbranch_vccz L_w69
  s_waitcnt vmcnt(4)
L_w69:
  s_addk_i32 s7, -4096
  buffer_load_dwordx4 v[208:211], v1, s[40:43], s7 offen nt
  ds_add_rtn_u32 v90, v88, v89 offset:2844
  v_mov_b32_dpp v12, v40 quad_perm:[0,0,0,0] row_mask:0xf bank_mask:0xf
  v_mov_b32_dpp v13, v44 quad_perm:[0,0,0,0] row_mask:0xf bank_mask:0xf
  v_mfma_f32_16x16x32_bf16 v[48:51], v[136:139], v[20:23], 0
  v_add_f32_dpp v12, v41, v12 quad_perm:[1,1,1,1] row_mask:0xf bank_mask:0xf
  v_add_f32_dpp v13, v45, v13 quad_perm:[1,1,1,1] row_mask:0xf bank_mask:0xf
  v_mfma_f32_16x16x32_bf16 v[52:55], v[108:111], v[20:23], 0
  v_add_f32_dpp v12, v42, v12 quad_perm:[2,2,2,2] row_mask:0xf bank_mask:0xf
  v_add_f32_dpp v13, v46, v13 quad_perm:[2,2,2,2] row_mask:0xf bank_mask:0xf
  s_nop 0
  v_add_f32_dpp v12, v43, v12 quad_perm:[3,3,3,3] row_mask:0xf bank_mask:0xf
  v_add_f32_dpp v13, v47, v13 quad_perm:[3,3,3,3] row_mask:0xf bank_mask:0xf
  v_max3_f32 v8, v12, v13, v8
  v_cvt_pk_bf16_f32 v14, v12, v13
  v_lshlrev_b32 v12, 16, v14
  v_and_b32 v13, s13, v14
  v_mul_f32 v12, s10, v12
  v_mul_f32 v13, s10, v13
  v_cvt_pk_bf16_f32 v70, v12, v13
  s_waitcnt vmcnt(5)
  s_waitcnt lgkmcnt(0)
  v_readfirstlane_b32 s27, v90
  s_nop 0
  s_lshr_b64 vcc, s[26:27], 63
  s_cbranch_vccz L_w70
  s_waitcnt vmcnt(4)
L_w70:
  s_addk_i32 s7, 8192
  buffer_load_dwordx4 v[212:215], v1, s[40:43], s7 offen nt
  v_mov_b32_dpp v12, v48 quad_perm:[0,0,0,0] row_mask:0xf bank_mask:0xf
  v_mov_b32_dpp v13, v52 quad_perm:[0,0,0,0] row_mask:0xf bank_mask:0xf
  v_mfma_f32_16x16x32_bf16 v[40:43], v[112:115], v[20:23], 0
  v_add_f32_dpp v12, v49, v12 quad_perm:[1,1,1,1] row_mask:0xf bank_mask:0xf
  v_add_f32_dpp v13, v53, v13 quad_perm:[1,1,1,1] row_mask:0xf bank_mask:0xf
  v_mfma_f32_16x16x32_bf16 v[44:47], v[140:143], v[20:23], 0
  v_add_f32_dpp v12, v50, v12 quad_perm:[2,2,2,2] row_mask:0xf bank_mask:0xf
  v_add_f32_dpp v13, v54, v13 quad_perm:[2,2,2,2] row_mask:0xf bank_mask:0xf
  s_nop 0
  v_add_f32_dpp v12, v51, v12 quad_perm:[3,3,3,3] row_mask:0xf bank_mask:0xf
  v_add_f32_dpp v13, v55, v13 quad_perm:[3,3,3,3] row_mask:0xf bank_mask:0xf
  v_max3_f32 v8, v12, v13, v8
  v_cvt_pk_bf16_f32 v14, v12, v13
  v_lshlrev_b32 v12, 16, v14
  v_and_b32 v13, s13, v14
  v_mul_f32 v12, s10, v12
  v_mul_f32 v13, s10, v13
  v_cvt_pk_bf16_f32 v71, v12, v13
  s_waitcnt vmcnt(5)
  s_cbranch_vccz L_w71
  s_waitcnt vmcnt(4)
L_w71:
  s_addk_i32 s7, 4096
  buffer_load_dwordx4 v[216:219], v1, s[40:43], s7 offen nt
  ds_add_rtn_u32 v90, v88, v89 offset:2844
  v_mov_b32_dpp v12, v40 quad_perm:[0,0,0,0] row_mask:0xf bank_mask:0xf
  v_mov_b32_dpp v13, v44 quad_perm:[0,0,0,0] row_mask:0xf bank_mask:0xf
  v_mfma_f32_16x16x32_bf16 v[48:51], v[116:119], v[20:23], 0
  v_add_f32_dpp v12, v41, v12 quad_perm:[1,1,1,1] row_mask:0xf bank_mask:0xf
  v_add_f32_dpp v13, v45, v13 quad_perm:[1,1,1,1] row_mask:0xf bank_mask:0xf
  v_mfma_f32_16x16x32_bf16 v[52:55], v[120:123], v[20:23], 0
  v_add_f32_dpp v12, v42, v12 quad_perm:[2,2,2,2] row_mask:0xf bank_mask:0xf
  v_add_f32_dpp v13, v46, v13 quad_perm:[2,2,2,2] row_mask:0xf bank_mask:0xf
  s_nop 0
  v_add_f32_dpp v12, v43, v12 quad_perm:[3,3,3,3] row_mask:0xf bank_mask:0xf
  v_add_f32_dpp v13, v47, v13 quad_perm:[3,3,3,3] row_mask:0xf bank_mask:0xf
  v_max3_f32 v8, v12, v13, v8
  v_cvt_pk_bf16_f32 v14, v12, v13
  v_lshlrev_b32 v12, 16, v14
  v_and_b32 v13, s13, v14
  v_mul_f32 v12, s10, v12
  v_mul_f32 v13, s10, v13
  v_cvt_pk_bf16_f32 v72, v12, v13
  s_waitcnt vmcnt(5)
  s_waitcnt lgkmcnt(0)
  v_readfirstlane_b32 s27, v90
  s_nop 0
  s_lshr_b64 vcc, s[26:27], 63
  s_cbranch_vccz L_w72
  s_waitcnt vmcnt(4)
L_w72:
  s_addk_i32 s7, 8192
  buffer_load_dwordx4 v[220:223], v1, s[40:43], s7 offen nt
  v_mov_b32_dpp v12, v48 quad_perm:[0,0,0,0] row_mask:0xf bank_mask:0xf
  v_mov_b32_dpp v13, v52 quad_perm:[0,0,0,0] row_mask:0xf bank_mask:0xf
  v_mfma_f32_16x16x32_bf16 v[40:43], v[144:147], v[20:23], 0
  v_add_f32_dpp v12, v49, v12 quad_perm:[1,1,1,1] row_mask:0xf bank_mask:0xf
  v_add_f32_dpp v13, v53, v13 quad_perm:[1,1,1,1] row_mask:0xf bank_mask:0xf
  v_mfma_f32_16x16x32_bf16 v[44:47], v[124:127], v[20:23], 0
  v_add_f32_dpp v12, v50, v12 quad_perm:[2,2,2,2] row_mask:0xf bank_mask:0xf
  v_add_f32_dpp v13, v54, v13 quad_perm:[2,2,2,2] row_mask:0xf bank_mask:0xf
  s_nop 0
  v_add_f32_dpp v12, v51, v12 quad_perm:[3,3,3,3] row_mask:0xf bank_mask:0xf
  v_add_f32_dpp v13, v55, v13 quad_perm:[3,3,3,3] row_mask:0xf bank_mask:0xf
  v_max3_f32 v8, v12, v13, v8
  v_cvt_pk_bf16_f32 v14, v12, v13
  v_lshlrev_b32 v12, 16, v14
  v_and_b32 v13, s13, v14
  v_mul_f32 v12, s10, v12
  v_mul_f32 v13, s10, v13
  v_cvt_pk_bf16_f32 v73, v12, v13
  s_waitcnt vmcnt(5)
  s_cbranch_vccz L_w73
  s_waitcnt vmcnt(4)
L_w73:
  s_addk_i32 s7, -4096
  buffer_load_dwordx4 v[224:227], v1, s[40:43], s7 offen nt
  ds_add_rtn_u32 v90, v88, v89 offset:2844
  v_mov_b32_dpp v12, v40 quad_perm:[0,0,0,0] row_mask:0xf bank_mask:0xf
  v_mov_b32_dpp v13, v44 quad_perm:[0,0,0,0] row_mask:0xf bank_mask:0xf
  v_mfma_f32_16x16x32_bf16 v[48:51], v[128:131], v[20:23], 0
  v_add_f32_dpp v12, v41, v12 quad_perm:[1,1,1,1] row_mask:0xf bank_mask:0xf
  v_add_f32_dpp v13, v45, v13 quad_perm:[1,1,1,1] row_mask:0xf bank_mask:0xf
  v_mfma_f32_16x16x32_bf16 v[52:55], v[148:151], v[20:23], 0
  v_add_f32_dpp v12, v42, v12 quad_perm:[2,2,2,2] row_mask:0xf bank_mask:0xf
  v_add_f32_dpp v13, v46, v13 quad_perm:[2,2,2,2] row_mask:0xf bank_mask:0xf
  s_nop 0
  v_add_f32_dpp v12, v43, v12 quad_perm:[3,3,3,3] row_mask:0xf bank_mask:0xf
  v_add_f32_dpp v13, v47, v13 quad_perm:[3,3,3,3] row_mask:0xf bank_mask:0xf
  v_max3_f32 v8, v12, v13, v8
  v_cvt_pk_bf16_f32 v14, v12, v13
  v_lshlrev_b32 v12, 16, v14
  v_and_b32 v13, s13, v14
  v_mul_f32 v12, s10, v12
  v_mul_f32 v13, s10, v13
  v_cvt_pk_bf16_f32 v74, v12, v13
  s_waitcnt vmcnt(5)
  s_waitcnt lgkmcnt(0)
  v_readfirstlane_b32 s27, v90
  s_nop 0
  s_lshr_b64 vcc, s[26:27], 63
  s_cbranch_vccz L_w74
  s_waitcnt vmcnt(4)
L_w74:
  s_addk_i32 s7, 8192
  buffer_load_dwordx4 v[228:231], v1, s[40:43], s7 offen nt
  v_mov_b32_dpp v12, v48 quad_perm:[0,0,0,0] row_mask:0xf bank_mask:0xf
  v_mov_b32_dpp v13, v52 quad_perm:[0,0,0,0] row_mask:0xf bank_mask:0xf
  v_mfma_f32_16x16x32_bf16 v[40:43], v[152:155], v[20:23], 0
  v_add_f32_dpp v12, v49, v12 quad_perm:[1,1,1,1] row_mask:0xf bank_mask:0xf
  v_add_f32_dpp v13, v53, v13 quad_perm:[1,1,1,1] row_mask:0xf bank_mask:0xf
  v_mfma_f32_16x16x32_bf16 v[44:47], v[156:159], v[20:23], 0
  v_add_f32_dpp v12, v50, v12 quad_perm:[2,2,2,2] row_mask:0xf bank_mask:0xf
  v_add_f32_dpp v13, v54, v13 quad_perm:[2,2,2,2] row_mask:0xf bank_mask:0xf
  s_nop 0
  v_add_f32_dpp v12, v51, v12 quad_perm:[3,3,3,3] row_mask:0xf bank_mask:0xf
  v_add_f32_dpp v13, v55, v13 quad_perm:[3,3,3,3] row_mask:0xf bank_mask:0xf
  v_max3_f32 v8, v12, v13, v8
  v_cvt_pk_bf16_f32 v14, v12, v13
  v_lshlrev_b32 v12, 16, v14
  v_and_b32 v13, s13, v14
  v_mul_f32 v12, s10, v12
  v_mul_f32 v13, s10, v13
  v_cvt_pk_bf16_f32 v75, v12, v13
  s_waitcnt vmcnt(5)
  s_cbranch_vccz L_w75
  s_waitcnt vmcnt(4)
L_w75:
  s_addk_i32 s7, 4096
  buffer_load_dwordx4 v[232:235], v1, s[40:43], s7 offen nt
  ds_add_rtn_u32 v90, v88, v89 offset:2844
  v_mov_b32_dpp v12, v40 quad_perm:[0,0,0,0] row_mask:0xf bank_mask:0xf
  v_mov_b32_dpp v13, v44 quad_perm:[0,0,0,0] row_mask:0xf bank_mask:0xf
  v_mfma_f32_16x16x32_bf16 v[48:51], v[160:163], v[20:23], 0
  v_add_f32_dpp v12, v41, v12 quad_perm:[1,1,1,1] row_mask:0xf bank_mask:0xf
  v_add_f32_dpp v13, v45, v13 quad_perm:[1,1,1,1] row_mask:0xf bank_mask:0xf
  v_mfma_f32_16x16x32_bf16 v[52:55], v[164:167], v[20:23], 0
  v_add_f32_dpp v12, v42, v12 quad_perm:[2,2,2,2] row_mask:0xf bank_mask:0xf
  v_add_f32_dpp v13, v46, v13 quad_perm:[2,2,2,2] row_mask:0xf bank_mask:0xf
  s_nop 0
  v_add_f32_dpp v12, v43, v12 quad_perm:[3,3,3,3] row_mask:0xf bank_mask:0xf
  v_add_f32_dpp v13, v47, v13 quad_perm:[3,3,3,3] row_mask:0xf bank_mask:0xf
  v_max3_f32 v8, v12, v13, v8
  v_cvt_pk_bf16_f32 v14, v12, v13
  v_lshlrev_b32 v12, 16, v14
  v_and_b32 v13, s13, v14
  v_mul_f32 v12, s10, v12
  v_mul_f32 v13, s10, v13
  v_cvt_pk_bf16_f32 v76, v12, v13
  s_waitcnt vmcnt(5)
  s_waitcnt lgkmcnt(0)
  v_readfirstlane_b32 s27, v90
  s_nop 0
  s_lshr_b64 vcc, s[26:27], 63
  s_cbranch_vccz L_w76
  s_waitcnt vmcnt(4)
L_w76:
  s_addk_i32 s7, 8192
  buffer_load_dwordx4 v[236:239], v1, s[40:43], s7 offen nt
  v_mov_b32_dpp v12, v48 quad_perm:[0,0,0,0] row_mask:0xf bank_mask:0xf
  v_mov_b32_dpp v13, v52 quad_perm:[0,0,0,0] row_mask:0xf bank_mask:0xf
  v_mfma_f32_16x16x32_bf16 v[40:43], v[168:171], v[20:23], 0
  v_add_f32_dpp v12, v49, v12 quad_perm:[1,1,1,1] row_mask:0xf bank_mask:0xf
  v_add_f32_dpp v13, v53, v13 quad_perm:[1,1,1,1] row_mask:0xf bank_mask:0xf
  v_mfma_f32_16x16x32_bf16 v[44:47], v[172:175], v[20:23], 0
  v_add_f32_dpp v12, v50, v12 quad_perm:[2,2,2,2] row_mask:0xf bank_mask:0xf
  v_add_f32_dpp v13, v54, v13 quad_perm:[2,2,2,2] row_mask:0xf bank_mask:0xf
  s_nop 0
  v_add_f32_dpp v12, v51, v12 quad_perm:[3,3,3,3] row_mask:0xf bank_mask:0xf
  v_add_f32_dpp v13, v55, v13 quad_perm:[3,3,3,3] row_mask:0xf bank_mask:0xf
  v_max3_f32 v8, v12, v13, v8
  v_cvt_pk_bf16_f32 v14, v12, v13
  v_lshlrev_b32 v12, 16, v14
  v_and_b32 v13, s13, v14
  v_mul_f32 v12, s10, v12
  v_mul_f32 v13, s10, v13
  v_cvt_pk_bf16_f32 v77, v12, v13
  s_waitcnt vmcnt(5)
  s_cbranch_vccz L_w77
  s_waitcnt vmcnt(4)
L_w77:
  s_addk_i32 s7, -4096
  buffer_load_dwordx4 v[240:243], v1, s[40:43], s7 offen nt
  ds_add_rtn_u32 v90, v88, v89 offset:2844
  v_mov_b32_dpp v12, v40 quad_perm:[0,0,0,0] row_mask:0xf bank_mask:0xf
  v_mov_b32_dpp v13, v44 quad_perm:[0,0,0,0] row_mask:0xf bank_mask:0xf
  v_mfma_f32_16x16x32_bf16 v[48:51], v[176:179], v[20:23], 0
  v_add_f32_dpp v12, v41, v12 quad_perm:[1,1,1,1] row_mask:0xf bank_mask:0xf
  v_add_f32_dpp v13, v45, v13 quad_perm:[1,1,1,1] row_mask:0xf bank_mask:0xf
  v_mfma_f32_16x16x32_bf16 v[52:55], v[180:183], v[20:23], 0
  v_add_f32_dpp v12, v42, v12 quad_perm:[2,2,2,2] row_mask:0xf bank_mask:0xf
  v_add_f32_dpp v13, v46, v13 quad_perm:[2,2,2,2] row_mask:0xf bank_mask:0xf
  s_nop 0
  v_add_f32_dpp v12, v43, v12 quad_perm:[3,3,3,3] row_mask:0xf bank_mask:0xf
  v_add_f32_dpp v13, v47, v13 quad_perm:[3,3,3,3] row_mask:0xf bank_mask:0xf
  v_max3_f32 v8, v12, v13, v8
  v_cvt_pk_bf16_f32 v14, v12, v13
  v_lshlrev_b32 v12, 16, v14
  v_and_b32 v13, s13, v14
  v_mul_f32 v12, s10, v12
  v_mul_f32 v13, s10, v13
  v_cvt_pk_bf16_f32 v78, v12, v13
  s_waitcnt vmcnt(5)
  s_waitcnt lgkmcnt(0)
  v_readfirstlane_b32 s27, v90
  s_nop 0
  s_lshr_b64 vcc, s[26:27], 63
  s_cbranch_vccz L_w78
  s_waitcnt vmcnt(4)
L_w78:
  s_addk_i32 s7, 8192
  buffer_load_dwordx4 v[244:247], v1, s[40:43], s7 offen nt
  v_mov_b32_dpp v12, v48 quad_perm:[0,0,0,0] row_mask:0xf bank_mask:0xf
  v_mov_b32_dpp v13, v52 quad_perm:[0,0,0,0] row_mask:0xf bank_mask:0xf
  v_mfma_f32_16x16x32_bf16 v[40:43], v[184:187], v[20:23], 0
  v_add_f32_dpp v12, v49, v12 quad_perm:[1,1,1,1] row_mask:0xf bank_mask:0xf
  v_add_f32_dpp v13, v53, v13 quad_perm:[1,1,1,1] row_mask:0xf bank_mask:0xf
  v_mfma_f32_16x16x32_bf16 v[44:47], v[188:191], v[20:23], 0
  v_add_f32_dpp v12, v50, v12 quad_perm:[2,2,2,2] row_mask:0xf bank_mask:0xf
  v_add_f32_dpp v13, v54, v13 quad_perm:[2,2,2,2] row_mask:0xf bank_mask:0xf
  s_nop 0
  v_add_f32_dpp v12, v51, v12 quad_perm:[3,3,3,3] row_mask:0xf bank_mask:0xf
  v_add_f32_dpp v13, v55, v13 quad_perm:[3,3,3,3] row_mask:0xf bank_mask:0xf
  v_max3_f32 v8, v12, v13, v8
  v_cvt_pk_bf16_f32 v14, v12, v13
  v_lshlrev_b32 v12, 16, v14
  v_and_b32 v13, s13, v14
  v_mul_f32 v12, s10, v12
  v_mul_f32 v13, s10, v13
  v_cvt_pk_bf16_f32 v79, v12, v13
  s_waitcnt vmcnt(5)
  s_cbranch_vccz L_w79
  s_waitcnt vmcnt(4)
L_w79:
  s_add_u32 s7, s7, 0xfffc1000
  buffer_load_dwordx4 v[248:251], v2, s[44:47], s7 offen nt
  ds_add_rtn_u32 v90, v88, v89 offset:2844
  v_mov_b32_dpp v12, v40 quad_perm:[0,0,0,0] row_mask:0xf bank_mask:0xf
  v_mov_b32_dpp v13, v44 quad_perm:[0,0,0,0] row_mask:0xf bank_mask:0xf
  v_mfma_f32_16x16x32_bf16 v[48:51], v[192:195], v[20:23], 0
  v_add_f32_dpp v12, v41, v12 quad_perm:[1,1,1,1] row_mask:0xf bank_mask:0xf
  v_add_f32_dpp v13, v45, v13 quad_perm:[1,1,1,1] row_mask:0xf bank_mask:0xf
  v_mfma_f32_16x16x32_bf16 v[52:55], v[196:199], v[20:23], 0
  v_add_f32_dpp v12, v42, v12 quad_perm:[2,2,2,2] row_mask:0xf bank_mask:0xf
  v_add_f32_dpp v13, v46, v13 quad_perm:[2,2,2,2] row_mask:0xf bank_mask:0xf
  s_nop 0
  v_add_f32_dpp v12, v43, v12 quad_perm:[3,3,3,3] row_mask:0xf bank_mask:0xf
  v_add_f32_dpp v13, v47, v13 quad_perm:[3,3,3,3] row_mask:0xf bank_mask:0xf
  v_max3_f32 v8, v12, v13, v8
  v_cvt_pk_bf16_f32 v14, v12, v13
  v_lshlrev_b32 v12, 16, v14
  v_and_b32 v13, s13, v14
  v_mul_f32 v12, s10, v12
  v_mul_f32 v13, s10, v13
  v_cvt_pk_bf16_f32 v80, v12, v13
  s_waitcnt vmcnt(5)
  s_waitcnt lgkmcnt(0)
  v_readfirstlane_b32 s27, v90
  s_nop 0
  s_lshr_b64 vcc, s[26:27], 63
  s_cbranch_vccz L_w80
  s_waitcnt vmcnt(4)
L_w80:
  s_addk_i32 s7, 8192
  buffer_load_dwordx4 v[92:95], v2, s[44:47], s7 offen nt
  v_mov_b32_dpp v12, v48 quad_perm:[0,0,0,0] row_mask:0xf bank_mask:0xf
  v_mov_b32_dpp v13, v52 quad_perm:[0,0,0,0] row_mask:0xf bank_mask:0xf
  v_mfma_f32_16x16x32_bf16 v[40:43], v[200:203], v[20:23], 0
  v_add_f32_dpp v12, v49, v12 quad_perm:[1,1,1,1] row_mask:0xf bank_mask:0xf
  v_add_f32_dpp v13, v53, v13 quad_perm:[1,1,1,1] row_mask:0xf bank_mask:0xf
  v_mfma_f32_16x16x32_bf16 v[44:47], v[204:207], v[20:23], 0
  v_add_f32_dpp v12, v50, v12 quad_perm:[2,2,2,2] row_mask:0xf bank_mask:0xf
  v_add_f32_dpp v13, v54, v13 quad_perm:[2,2,2,2] row_mask:0xf bank_mask:0xf
  s_nop 0
  v_add_f32_dpp v12, v51, v12 quad_perm:[3,3,3,3] row_mask:0xf bank_mask:0xf
  v_add_f32_dpp v13, v55, v13 quad_perm:[3,3,3,3] row_mask:0xf bank_mask:0xf
  v_max3_f32 v8, v12, v13, v8
  v_cvt_pk_bf16_f32 v14, v12, v13
  v_lshlrev_b32 v12, 16, v14
  v_and_b32 v13, s13, v14
  v_mul_f32 v12, s10, v12
  v_mul_f32 v13, s10, v13
  v_cvt_pk_bf16_f32 v81, v12, v13
  s_waitcnt vmcnt(5)
  s_cbranch_vccz L_w81
  s_waitcnt vmcnt(4)
L_w81:
  s_addk_i32 s7, -4096
  buffer_load_dwordx4 v[96:99], v2, s[44:47], s7 offen nt
  ds_add_rtn_u32 v90, v88, v89 offset:2844
  v_mov_b32_dpp v12, v40 quad_perm:[0,0,0,0] row_mask:0xf bank_mask:0xf
  v_mov_b32_dpp v13, v44 quad_perm:[0,0,0,0] row_mask:0xf bank_mask:0xf
  v_mfma_f32_16x16x32_bf16 v[48:51], v[208:211], v[20:23], 0
  v_add_f32_dpp v12, v41, v12 quad_perm:[1,1,1,1] row_mask:0xf bank_mask:0xf
  v_add_f32_dpp v13, v45, v13 quad_perm:[1,1,1,1] row_mask:0xf bank_mask:0xf
  v_mfma_f32_16x16x32_bf16 v[52:55], v[212:215], v[20:23], 0
  v_add_f32_dpp v12, v42, v12 quad_perm:[2,2,2,2] row_mask:0xf bank_mask:0xf
  v_add_f32_dpp v13, v46, v13 quad_perm:[2,2,2,2] row_mask:0xf bank_mask:0xf
  s_nop 0
  v_add_f32_dpp v12, v43, v12 quad_perm:[3,3,3,3] row_mask:0xf bank_mask:0xf
  v_add_f32_dpp v13, v47, v13 quad_perm:[3,3,3,3] row_mask:0xf bank_mask:0xf
  v_max3_f32 v8, v12, v13, v8
  v_cvt_pk_bf16_f32 v14, v12, v13
  v_lshlrev_b32 v12, 16, v14
  v_and_b32 v13, s13, v14
  v_mul_f32 v12, s10, v12
  v_mul_f32 v13, s10, v13
  v_cvt_pk_bf16_f32 v82, v12, v13
  s_waitcnt vmcnt(5)
  s_waitcnt lgkmcnt(0)
  v_readfirstlane_b32 s27, v90
  s_nop 0
  s_lshr_b64 vcc, s[26:27], 63
  s_cbranch_vccz L_w82
  s_waitcnt vmcnt(4)
L_w82:
  s_addk_i32 s7, 8192
  buffer_load_dwordx4 v[132:135], v2, s[44:47], s7 offen nt
  v_mov_b32_dpp v12, v48 quad_perm:[0,0,0,0] row_mask:0xf bank_mask:0xf
  v_mov_b32_dpp v13, v52 quad_perm:[0,0,0,0] row_mask:0xf bank_mask:0xf
  v_mfma_f32_16x16x32_bf16 v[40:43], v[216:219], v[20:23], 0
  v_add_f32_dpp v12, v49, v12 quad_perm:[1,1,1,1] row_mask:0xf bank_mask:0xf
  v_add_f32_dpp v13, v53, v13 quad_perm:[1,1,1,1] row_mask:0xf bank_mask:0xf
  v_mfma_f32_16x16x32_bf16 v[44:47], v[220:223], v[20:23], 0
  v_add_f32_dpp v12, v50, v12 quad_perm:[2,2,2,2] row_mask:0xf bank_mask:0xf
  v_add_f32_dpp v13, v54, v13 quad_perm:[2,2,2,2] row_mask:0xf bank_mask:0xf
  s_nop 0
  v_add_f32_dpp v12, v51, v12 quad_perm:[3,3,3,3] row_mask:0xf bank_mask:0xf
  v_add_f32_dpp v13, v55, v13 quad_perm:[3,3,3,3] row_mask:0xf bank_mask:0xf
  v_max3_f32 v8, v12, v13, v8
  v_cvt_pk_bf16_f32 v14, v12, v13
  v_lshlrev_b32 v12, 16, v14
  v_and_b32 v13, s13, v14
  v_mul_f32 v12, s10, v12
  v_mul_f32 v13, s10, v13
  v_cvt_pk_bf16_f32 v83, v12, v13
  s_waitcnt vmcnt(5)
  s_cbranch_vccz L_w83
  s_waitcnt vmcnt(4)
L_w83:
  s_addk_i32 s7, 4096
  buffer_load_dwordx4 v[100:103], v2, s[44:47], s7 offen nt
  ds_add_rtn_u32 v90, v88, v89 offset:2844
  v_mov_b32_dpp v12, v40 quad_perm:[0,0,0,0] row_mask:0xf bank_mask:0xf
  v_mov_b32_dpp v13, v44 quad_perm:[0,0,0,0] row_mask:0xf bank_mask:0xf
  v_mfma_f32_16x16x32_bf16 v[48:51], v[224:227], v[20:23], 0
  v_add_f32_dpp v12, v41, v12 quad_perm:[1,1,1,1] row_mask:0xf bank_mask:0xf
  v_add_f32_dpp v13, v45, v13 quad_perm:[1,1,1,1] row_mask:0xf bank_mask:0xf
  v_mfma_f32_16x16x32_bf16 v[52:55], v[228:231], v[20:23], 0
  v_add_f32_dpp v12, v42, v12 quad_perm:[2,2,2,2] row_mask:0xf bank_mask:0xf
  v_add_f32_dpp v13, v46, v13 quad_perm:[2,2,2,2] row_mask:0xf bank_mask:0xf
  s_nop 0
  v_add_f32_dpp v12, v43, v12 quad_perm:[3,3,3,3] row_mask:0xf bank_mask:0xf
  v_add_f32_dpp v13, v47, v13 quad_perm:[3,3,3,3] row_mask:0xf bank_mask:0xf
  v_max3_f32 v8, v12, v13, v8
  v_cvt_pk_bf16_f32 v14, v12, v13
  v_lshlrev_b32 v12, 16, v14
  v_and_b32 v13, s13, v14
  v_mul_f32 v12, s10, v12
  v_mul_f32 v13, s10, v13
  v_cvt_pk_bf16_f32 v84, v12, v13
  s_waitcnt vmcnt(5)
  s_waitcnt lgkmcnt(0)
  v_readfirstlane_b32 s27, v90
  s_nop 0
  s_lshr_b64 vcc, s[26:27], 63
  s_cbranch_vccz L_w84
  s_waitcnt vmcnt(4)
L_w84:
  s_addk_i32 s7, 8192
  buffer_load_dwordx4 v[104:107], v2, s[44:47], s7 offen nt
  v_mov_b32_dpp v12, v48 quad_perm:[0,0,0,0] row_mask:0xf bank_mask:0xf
  v_mov_b32_dpp v13, v52 quad_perm:[0,0,0,0] row_mask:0xf bank_mask:0xf
  v_mfma_f32_16x16x32_bf16 v[40:43], v[232:235], v[20:23], 0
  v_add_f32_dpp v12, v49, v12 quad_perm:[1,1,1,1] row_mask:0xf bank_mask:0xf
  v_add_f32_dpp v13, v53, v13 quad_perm:[1,1,1,1] row_mask:0xf bank_mask:0xf
  v_mfma_f32_16x16x32_bf16 v[44:47], v[236:239], v[20:23], 0
  v_add_f32_dpp v12, v50, v12 quad_perm:[2,2,2,2] row_mask:0xf bank_mask:0xf
  v_add_f32_dpp v13, v54, v13 quad_perm:[2,2,2,2] row_mask:0xf bank_mask:0xf
  s_nop 0
  v_add_f32_dpp v12, v51, v12 quad_perm:[3,3,3,3] row_mask:0xf bank_mask:0xf
  v_add_f32_dpp v13, v55, v13 quad_perm:[3,3,3,3] row_mask:0xf bank_mask:0xf
  v_max3_f32 v8, v12, v13, v8
  v_cvt_pk_bf16_f32 v14, v12, v13
  v_lshlrev_b32 v12, 16, v14
  v_and_b32 v13, s13, v14
  v_mul_f32 v12, s10, v12
  v_mul_f32 v13, s10, v13
  v_cvt_pk_bf16_f32 v85, v12, v13
  s_waitcnt vmcnt(5)
  s_cbranch_vccz L_w85
  s_waitcnt vmcnt(4)
L_w85:
  s_addk_i32 s7, -4096
  buffer_load_dwordx4 v[136:139], v2, s[44:47], s7 offen nt
  ds_add_rtn_u32 v90, v88, v89 offset:2844
  v_mov_b32_dpp v12, v40 quad_perm:[0,0,0,0] row_mask:0xf bank_mask:0xf
  v_mov_b32_dpp v13, v44 quad_perm:[0,0,0,0] row_mask:0xf bank_mask:0xf
  v_mfma_f32_16x16x32_bf16 v[48:51], v[240:243], v[20:23], 0
  v_add_f32_dpp v12, v41, v12 quad_perm:[1,1,1,1] row_mask:0xf bank_mask:0xf
  v_add_f32_dpp v13, v45, v13 quad_perm:[1,1,1,1] row_mask:0xf bank_mask:0xf
  v_mfma_f32_16x16x32_bf16 v[52:55], v[244:247], v[20:23], 0
  v_add_f32_dpp v12, v42, v12 quad_perm:[2,2,2,2] row_mask:0xf bank_mask:0xf
  v_add_f32_dpp v13, v46, v13 quad_perm:[2,2,2,2] row_mask:0xf bank_mask:0xf
  s_nop 0
  v_add_f32_dpp v12, v43, v12 quad_perm:[3,3,3,3] row_mask:0xf bank_mask:0xf
  v_add_f32_dpp v13, v47, v13 quad_perm:[3,3,3,3] row_mask:0xf bank_mask:0xf
  v_max3_f32 v8, v12, v13, v8
  v_cvt_pk_bf16_f32 v14, v12, v13
  v_lshlrev_b32 v12, 16, v14
  v_and_b32 v13, s13, v14
  v_mul_f32 v12, s10, v12
  v_mul_f32 v13, s10, v13
  v_cvt_pk_bf16_f32 v86, v12, v13
  s_waitcnt vmcnt(5)
  s_waitcnt lgkmcnt(0)
  v_readfirstlane_b32 s27, v90
  s_nop 0
  s_lshr_b64 vcc, s[26:27], 63
  s_cbranch_vccz L_w86
  s_waitcnt vmcnt(4)
L_w86:
  s_addk_i32 s7, 8192
  buffer_load_dwordx4 v[108:111], v2, s[44:47], s7 offen nt
  v_mov_b32_dpp v12, v48 quad_perm:[0,0,0,0] row_mask:0xf bank_mask:0xf
  v_mov_b32_dpp v13, v52 quad_perm:[0,0,0,0] row_mask:0xf bank_mask:0xf
  s_nop 0
  v_add_f32_dpp v12, v49, v12 quad_perm:[1,1,1,1] row_mask:0xf bank_mask:0xf
  v_add_f32_dpp v13, v53, v13 quad_perm:[1,1,1,1] row_mask:0xf bank_mask:0xf
  s_nop 0
  v_add_f32_dpp v12, v50, v12 quad_perm:[2,2,2,2] row_mask:0xf bank_mask:0xf
  v_add_f32_dpp v13, v54, v13 quad_perm:[2,2,2,2] row_mask:0xf bank_mask:0xf
  s_nop 0
  v_add_f32_dpp v12, v51, v12 quad_perm:[3,3,3,3] row_mask:0xf bank_mask:0xf
  v_add_f32_dpp v13, v55, v13 quad_perm:[3,3,3,3] row_mask:0xf bank_mask:0xf
  v_max3_f32 v8, v12, v13, v8
  v_cvt_pk_bf16_f32 v14, v12, v13
  v_lshlrev_b32 v12, 16, v14
  v_and_b32 v13, s13, v14
  v_mul_f32 v12, s10, v12
  v_mul_f32 v13, s10, v13
  v_cvt_pk_bf16_f32 v87, v12, v13
  s_waitcnt vmcnt(5)
  s_cbranch_vccz L_w87
  s_waitcnt vmcnt(4)
L_w87:
  s_addk_i32 s7, 4096
  buffer_load_dwordx4 v[112:115], v2, s[44:47], s7 offen nt
  ds_add_rtn_u32 v90, v88, v89 offset:2844
  v_mov_b32 v12, v8
  s_nop 1
  v_permlane32_swap_b32 v8, v12
  v_max_f32 v8, v8, v12
  v_mov_b32 v12, v8
  s_nop 1
  v_permlane16_swap_b32 v8, v12
  v_max_f32 v8, v8, v12
  v_cvt_pk_bf16_f32 v14, v8, v8
  v_lshlrev_b32 v8, 16, v14
  v_mul_f32 v8, s10, v8
  v_cvt_pk_bf16_f32 v14, v8, v8
  v_lshlrev_b32 v8, 16, v14
  v_mul_f32 v10, s9, v8
  s_waitcnt vmcnt(5)
  s_waitcnt lgkmcnt(0)
  v_readfirstlane_b32 s27, v90
  s_nop 0
  s_lshr_b64 vcc, s[26:27], 63
  s_cbranch_vccz L_w88
  s_waitcnt vmcnt(4)
L_w88:
  s_addk_i32 s7, 8192
  buffer_load_dwordx4 v[140:143], v2, s[44:47], s7 offen nt
  v_lshlrev_b32 v12, 16, v56
  v_and_b32 v13, s13, v56
  v_fma_f32 v12, v12, s9, -v10
  v_fma_f32 v13, v13, s9, -v10
  v_exp_f32 v12, v12
  v_exp_f32 v13, v13
  v_add_f32 v9, v9, v12
  v_cvt_pk_bf16_f32 v56, v12, v13
  v_add_f32 v9, v9, v13
  v_lshlrev_b32 v12, 16, v57
  v_and_b32 v13, s13, v57
  v_fma_f32 v12, v12, s9, -v10
  v_fma_f32 v13, v13, s9, -v10
  v_exp_f32 v12, v12
  v_exp_f32 v13, v13
  v_add_f32 v9, v9, v12
  v_cvt_pk_bf16_f32 v57, v12, v13
  v_add_f32 v9, v9, v13
  s_waitcnt vmcnt(5)
  s_cbranch_vccz L_w89
  s_waitcnt vmcnt(4)
L_w89:
  s_addk_i32 s7, -4096
  buffer_load_dwordx4 v[116:119], v2, s[44:47], s7 offen nt
  ds_add_rtn_u32 v90, v88, v89 offset:2844
  v_lshlrev_b32 v12, 16, v58
  v_and_b32 v13, s13, v58
  v_fma_f32 v12, v12, s9, -v10
  v_fma_f32 v13, v13, s9, -v10
  v_exp_f32 v12, v12
  v_exp_f32 v13, v13
  v_add_f32 v9, v9, v12
  v_cvt_pk_bf16_f32 v58, v12, v13
  v_add_f32 v9, v9, v13
  v_lshlrev_b32 v12, 16, v59
  v_and_b32 v13, s13, v59
  v_fma_f32 v12, v12, s9, -v10
  v_fma_f32 v13, v13, s9, -v10
  v_exp_f32 v12, v12
  v_exp_f32 v13, v13
  v_add_f32 v9, v9, v12
  v_cvt_pk_bf16_f32 v59, v12, v13
  v_add_f32 v9, v9, v13
  s_waitcnt vmcnt(5)
  s_waitcnt lgkmcnt(0)
  v_readfirstlane_b32 s27, v90
  s_nop 0
  s_lshr_b64 vcc, s[26:27], 63
  s_cbranch_vccz L_w90
  s_waitcnt vmcnt(4)
L_w90:
  s_addk_i32 s7, 8192
  buffer_load_dwordx4 v[120:123], v2, s[44:47], s7 offen nt
  v_lshlrev_b32 v12, 16, v60
  v_and_b32 v13, s13, v60
  v_fma_f32 v12, v12, s9, -v10
  v_fma_f32 v13, v13, s9, -v10
  v_exp_f32 v12, v12
  v_exp_f32 v13, v13
  v_add_f32 v9, v9, v12
  v_cvt_pk_bf16_f32 v60, v12, v13
  v_add_f32 v9, v9, v13
  v_lshlrev_b32 v12, 16, v61
  v_and_b32 v13, s13, v61
  v_fma_f32 v12, v12, s9, -v10
  v_fma_f32 v13, v13, s9, -v10
  v_exp_f32 v12, v12
  v_exp_f32 v13, v13
  v_add_f32 v9, v9, v12
  v_cvt_pk_bf16_f32 v61, v12, v13
  v_add_f32 v9, v9, v13
  s_waitcnt vmcnt(5)
  s_cbranch_vccz L_w91
  s_waitcnt vmcnt(4)
L_w91:
  s_addk_i32 s7, 4096
  buffer_load_dwordx4 v[144:147], v2, s[44:47], s7 offen nt
  ds_add_rtn_u32 v90, v88, v89 offset:2844
  v_lshlrev_b32 v12, 16, v62
  v_and_b32 v13, s13, v62
  v_fma_f32 v12, v12, s9, -v10
  v_fma_f32 v13, v13, s9, -v10
  v_exp_f32 v12, v12
  v_exp_f32 v13, v13
  v_add_f32 v9, v9, v12
  v_cvt_pk_bf16_f32 v62, v12, v13
  v_add_f32 v9, v9, v13
  v_lshlrev_b32 v12, 16, v63
  v_and_b32 v13, s13, v63
  v_fma_f32 v12, v12, s9, -v10
  v_fma_f32 v13, v13, s9, -v10
  v_exp_f32 v12, v12
  v_exp_f32 v13, v13
  v_add_f32 v9, v9, v12
  v_cvt_pk_bf16_f32 v63, v12, v13
  v_add_f32 v9, v9, v13
  s_waitcnt vmcnt(5)
  s_waitcnt lgkmcnt(0)
  v_readfirstlane_b32 s27, v90
  s_nop 0
  s_lshr_b64 vcc, s[26:27], 63
  s_cbranch_vccz L_w92
  s_waitcnt vmcnt(4)
L_w92:
  s_addk_i32 s7, 8192
  buffer_load_dwordx4 v[124:127], v2, s[44:47], s7 offen nt
  v_lshlrev_b32 v12, 16, v64
  v_and_b32 v13, s13, v64
  v_fma_f32 v12, v12, s9, -v10
  v_fma_f32 v13, v13, s9, -v10
  v_exp_f32 v12, v12
  v_exp_f32 v13, v13
  v_add_f32 v9, v9, v12
  v_cvt_pk_bf16_f32 v64, v12, v13
  v_add_f32 v9, v9, v13
  v_lshlrev_b32 v12, 16, v65
  v_and_b32 v13, s13, v65
  v_fma_f32 v12, v12, s9, -v10
  v_fma_f32 v13, v13, s9, -v10
  v_exp_f32 v12, v12
  v_exp_f32 v13, v13
  v_add_f32 v9, v9, v12
  v_cvt_pk_bf16_f32 v65, v12, v13
  v_add_f32 v9, v9, v13
  s_waitcnt vmcnt(5)
  s_cbranch_vccz L_w93
  s_waitcnt vmcnt(4)
L_w93:
  s_addk_i32 s7, -4096
  buffer_load_dwordx4 v[128:131], v2, s[44:47], s7 offen nt
  ds_add_rtn_u32 v90, v88, v89 offset:2844
  v_lshlrev_b32 v12, 16, v66
  v_and_b32 v13, s13, v66
  v_fma_f32 v12, v12, s9, -v10
  v_fma_f32 v13, v13, s9, -v10
  v_exp_f32 v12, v12
  v_exp_f32 v13, v13
  v_add_f32 v9, v9, v12
  v_cvt_pk_bf16_f32 v66, v12, v13
  v_add_f32 v9, v9, v13
  v_lshlrev_b32 v12, 16, v67
  v_and_b32 v13, s13, v67
  v_fma_f32 v12, v12, s9, -v10
  v_fma_f32 v13, v13, s9, -v10
  v_exp_f32 v12, v12
  v_exp_f32 v13, v13
  v_add_f32 v9, v9, v12
  v_cvt_pk_bf16_f32 v67, v12, v13
  v_add_f32 v9, v9, v13
  s_waitcnt vmcnt(5)
  s_waitcnt lgkmcnt(0)
  v_readfirstlane_b32 s27, v90
  s_nop 0
  s_lshr_b64 vcc, s[26:27], 63
  s_cbranch_vccz L_w94
  s_waitcnt vmcnt(4)
L_w94:
  s_addk_i32 s7, 8192
  buffer_load_dwordx4 v[148:151], v2, s[44:47], s7 offen nt
  v_lshlrev_b32 v12, 16, v68
  v_and_b32 v13, s13, v68
  v_fma_f32 v12, v12, s9, -v10
  v_fma_f32 v13, v13, s9, -v10
  v_exp_f32 v12, v12
  v_exp_f32 v13, v13
  v_add_f32 v9, v9, v12
  v_cvt_pk_bf16_f32 v68, v12, v13
  v_add_f32 v9, v9, v13
  v_lshlrev_b32 v12, 16, v69
  v_and_b32 v13, s13, v69
  v_fma_f32 v12, v12, s9, -v10
  v_fma_f32 v13, v13, s9, -v10
  v_exp_f32 v12, v12
  v_exp_f32 v13, v13
  v_add_f32 v9, v9, v12
  v_cvt_pk_bf16_f32 v69, v12, v13
  v_add_f32 v9, v9, v13
  s_waitcnt vmcnt(5)
  s_cbranch_vccz L_w95
  s_waitcnt vmcnt(4)
L_w95:
  s_addk_i32 s7, 4096
  buffer_load_dwordx4 v[152:155], v2, s[44:47], s7 offen nt
  ds_add_rtn_u32 v90, v88, v89 offset:2844
  v_lshlrev_b32 v12, 16, v70
  v_and_b32 v13, s13, v70
  v_fma_f32 v12, v12, s9, -v10
  v_fma_f32 v13, v13, s9, -v10
  v_exp_f32 v12, v12
  v_exp_f32 v13, v13
  v_add_f32 v9, v9, v12
  v_cvt_pk_bf16_f32 v70, v12, v13
  v_add_f32 v9, v9, v13
  v_lshlrev_b32 v12, 16, v71
  v_and_b32 v13, s13, v71
  v_fma_f32 v12, v12, s9, -v10
  v_fma_f32 v13, v13, s9, -v10
  v_exp_f32 v12, v12
  v_exp_f32 v13, v13
  v_add_f32 v9, v9, v12
  v_cvt_pk_bf16_f32 v71, v12, v13
  v_add_f32 v9, v9, v13
  s_waitcnt vmcnt(5)
  s_waitcnt lgkmcnt(0)
  v_readfirstlane_b32 s27, v90
  s_nop 0
  s_lshr_b64 vcc, s[26:27], 63
  s_cbranch_vccz L_w96
  s_waitcnt vmcnt(4)
L_w96:
  s_addk_i32 s7, 8192
  buffer_load_dwordx4 v[156:159], v2, s[44:47], s7 offen nt
  v_lshlrev_b32 v12, 16, v72
  v_and_b32 v13, s13, v72
  v_fma_f32 v12, v12, s9, -v10
  v_fma_f32 v13, v13, s9, -v10
  v_exp_f32 v12, v12
  v_exp_f32 v13, v13
  v_add_f32 v9, v9, v12
  v_cvt_pk_bf16_f32 v72, v12, v13
  v_add_f32 v9, v9, v13
  v_lshlrev_b32 v12, 16, v73
  v_and_b32 v13, s13, v73
  v_fma_f32 v12, v12, s9, -v10
  v_fma_f32 v13, v13, s9, -v10
  v_exp_f32 v12, v12
  v_exp_f32 v13, v13
  v_add_f32 v9, v9, v12
  v_cvt_pk_bf16_f32 v73, v12, v13
  v_add_f32 v9, v9, v13
  s_waitcnt vmcnt(5)
  s_cbranch_vccz L_w97
  s_waitcnt vmcnt(4)
L_w97:
  s_addk_i32 s7, -4096
  buffer_load_dwordx4 v[160:163], v2, s[44:47], s7 offen nt
  ds_add_rtn_u32 v90, v88, v89 offset:2844
  v_lshlrev_b32 v12, 16, v74
  v_and_b32 v13, s13, v74
  v_fma_f32 v12, v12, s9, -v10
  v_fma_f32 v13, v13, s9, -v10
  v_exp_f32 v12, v12
  v_exp_f32 v13, v13
  v_add_f32 v9, v9, v12
  v_cvt_pk_bf16_f32 v74, v12, v13
  v_add_f32 v9, v9, v13
  v_lshlrev_b32 v12, 16, v75
  v_and_b32 v13, s13, v75
  v_fma_f32 v12, v12, s9, -v10
  v_fma_f32 v13, v13, s9, -v10
  v_exp_f32 v12, v12
  v_exp_f32 v13, v13
  v_add_f32 v9, v9, v12
  v_cvt_pk_bf16_f32 v75, v12, v13
  v_add_f32 v9, v9, v13
  s_waitcnt vmcnt(5)
  s_waitcnt lgkmcnt(0)
  v_readfirstlane_b32 s27, v90
  s_nop 0
  s_lshr_b64 vcc, s[26:27], 63
  s_cbranch_vccz L_w98
  s_waitcnt vmcnt(4)
L_w98:
  s_addk_i32 s7, 8192
  buffer_load_dwordx4 v[164:167], v2, s[44:47], s7 offen nt
  v_lshlrev_b32 v12, 16, v76
  v_and_b32 v13, s13, v76
  v_fma_f32 v12, v12, s9, -v10
  v_fma_f32 v13, v13, s9, -v10
  v_exp_f32 v12, v12
  v_exp_f32 v13, v13
  v_add_f32 v9, v9, v12
  v_cvt_pk_bf16_f32 v76, v12, v13
  v_add_f32 v9, v9, v13
  v_lshlrev_b32 v12, 16, v77
  v_and_b32 v13, s13, v77
  v_fma_f32 v12, v12, s9, -v10
  v_fma_f32 v13, v13, s9, -v10
  v_exp_f32 v12, v12
  v_exp_f32 v13, v13
  v_add_f32 v9, v9, v12
  v_cvt_pk_bf16_f32 v77, v12, v13
  v_add_f32 v9, v9, v13
  s_waitcnt vmcnt(5)
  s_cbranch_vccz L_w99
  s_waitcnt vmcnt(4)
L_w99:
  s_addk_i32 s7, 4096
  buffer_load_dwordx4 v[168:171], v2, s[44:47], s7 offen nt
  ds_add_rtn_u32 v90, v88, v89 offset:2844
  v_lshlrev_b32 v12, 16, v78
  v_and_b32 v13, s13, v78
  v_fma_f32 v12, v12, s9, -v10
  v_fma_f32 v13, v13, s9, -v10
  v_exp_f32 v12, v12
  v_exp_f32 v13, v13
  v_add_f32 v9, v9, v12
  v_cvt_pk_bf16_f32 v78, v12, v13
  v_add_f32 v9, v9, v13
  v_lshlrev_b32 v12, 16, v79
  v_and_b32 v13, s13, v79
  v_fma_f32 v12, v12, s9, -v10
  v_fma_f32 v13, v13, s9, -v10
  v_exp_f32 v12, v12
  v_exp_f32 v13, v13
  v_add_f32 v9, v9, v12
  v_cvt_pk_bf16_f32 v79, v12, v13
  v_add_f32 v9, v9, v13
  s_waitcnt vmcnt(5)
  s_waitcnt lgkmcnt(0)
  v_readfirstlane_b32 s27, v90
  s_nop 0
  s_lshr_b64 vcc, s[26:27], 63
  s_cbranch_vccz L_w100
  s_waitcnt vmcnt(4)
L_w100:
  s_addk_i32 s7, 8192
  buffer_load_dwordx4 v[172:175], v2, s[44:47], s7 offen nt
  v_lshlrev_b32 v12, 16, v80
  v_and_b32 v13, s13, v80
  v_fma_f32 v12, v12, s9, -v10
  v_fma_f32 v13, v13, s9, -v10
  v_exp_f32 v12, v12
  v_exp_f32 v13, v13
  v_add_f32 v9, v9, v12
  v_cvt_pk_bf16_f32 v80, v12, v13
  v_add_f32 v9, v9, v13
  v_lshlrev_b32 v12, 16, v81
  v_and_b32 v13, s13, v81
  v_fma_f32 v12, v12, s9, -v10
  v_fma_f32 v13, v13, s9, -v10
  v_exp_f32 v12, v12
  v_exp_f32 v13, v13
  v_add_f32 v9, v9, v12
  v_cvt_pk_bf16_f32 v81, v12, v13
  v_add_f32 v9, v9, v13
  s_waitcnt vmcnt(5)
  s_cbranch_vccz L_w101
  s_waitcnt vmcnt(4)
L_w101:
  s_addk_i32 s7, -4096
  buffer_load_dwordx4 v[176:179], v2, s[44:47], s7 offen nt
  ds_add_rtn_u32 v90, v88, v89 offset:2844
  v_lshlrev_b32 v12, 16, v82
  v_and_b32 v13, s13, v82
  v_fma_f32 v12, v12, s9, -v10
  v_fma_f32 v13, v13, s9, -v10
  v_exp_f32 v12, v12
  v_exp_f32 v13, v13
  v_add_f32 v9, v9, v12
  v_cvt_pk_bf16_f32 v82, v12, v13
  v_add_f32 v9, v9, v13
  v_lshlrev_b32 v12, 16, v83
  v_and_b32 v13, s13, v83
  v_fma_f32 v12, v12, s9, -v10
  v_fma_f32 v13, v13, s9, -v10
  v_exp_f32 v12, v12
  v_exp_f32 v13, v13
  v_add_f32 v9, v9, v12
  v_cvt_pk_bf16_f32 v83, v12, v13
  v_add_f32 v9, v9, v13
  s_waitcnt vmcnt(5)
  s_waitcnt lgkmcnt(0)
  v_readfirstlane_b32 s27, v90
  s_nop 0
  s_lshr_b64 vcc, s[26:27], 63
  s_cbranch_vccz L_w102
  s_waitcnt vmcnt(4)
L_w102:
  s_addk_i32 s7, 8192
  buffer_load_dwordx4 v[180:183], v2, s[44:47], s7 offen nt
  v_lshlrev_b32 v12, 16, v84
  v_and_b32 v13, s13, v84
  v_fma_f32 v12, v12, s9, -v10
  v_fma_f32 v13, v13, s9, -v10
  v_exp_f32 v12, v12
  v_exp_f32 v13, v13
  v_add_f32 v9, v9, v12
  v_cvt_pk_bf16_f32 v84, v12, v13
  v_add_f32 v9, v9, v13
  v_lshlrev_b32 v12, 16, v85
  v_and_b32 v13, s13, v85
  v_fma_f32 v12, v12, s9, -v10
  v_fma_f32 v13, v13, s9, -v10
  v_exp_f32 v12, v12
  v_exp_f32 v13, v13
  v_add_f32 v9, v9, v12
  v_cvt_pk_bf16_f32 v85, v12, v13
  v_add_f32 v9, v9, v13
  s_waitcnt vmcnt(5)
  s_cbranch_vccz L_w103
  s_waitcnt vmcnt(4)
L_w103:
  s_addk_i32 s7, 4096
  buffer_load_dwordx4 v[184:187], v2, s[44:47], s7 offen nt
  ds_add_rtn_u32 v90, v88, v89 offset:2844
  v_lshlrev_b32 v12, 16, v86
  v_and_b32 v13, s13, v86
  v_fma_f32 v12, v12, s9, -v10
  v_fma_f32 v13, v13, s9, -v10
  v_exp_f32 v12, v12
  v_exp_f32 v13, v13
  v_add_f32 v9, v9, v12
  v_cvt_pk_bf16_f32 v86, v12, v13
  v_add_f32 v9, v9, v13
  v_lshlrev_b32 v12, 16, v87
  v_and_b32 v13, s13, v87
  v_fma_f32 v12, v12, s9, -v10
  v_fma_f32 v13, v13, s9, -v10
  v_exp_f32 v12, v12
  v_exp_f32 v13, v13
  v_add_f32 v9, v9, v12
  v_cvt_pk_bf16_f32 v87, v12, v13
  v_add_f32 v9, v9, v13
  s_waitcnt vmcnt(5)
  s_waitcnt lgkmcnt(0)
  v_readfirstlane_b32 s27, v90
  s_nop 0
  s_lshr_b64 vcc, s[26:27], 63
  s_cbranch_vccz L_w104
  s_waitcnt vmcnt(4)
L_w104:
  s_addk_i32 s7, 8192
  buffer_load_dwordx4 v[188:191], v2, s[44:47], s7 offen nt
  v_mov_b32 v12, v9
  s_nop 1
  v_permlane32_swap_b32 v9, v12
  v_add_f32 v9, v9, v12
  v_mov_b32 v12, v9
  s_nop 1
  v_permlane16_swap_b32 v9, v12
  v_add_f32 v9, v9, v12
  s_lshl_b32 s14, s3, 3
  v_add_u32 v12, s14, v88
  s_mov_b64 exec, 0x101
  ds_write_b64 v12, v[8:9] offset:3200
  s_mov_b64 exec, 1
  ds_add_u32 v7, v89 offset:2824
  s_mov_b64 exec, -1
  s_lshl_b32 s14, s3, 10
  v_add_u32 v10, s14, v2
  v_perm_b32 v14, v56, v56, s11
  v_and_b32 v28, v16, v14
  v_and_b32 v29, v17, v14
  v_and_b32 v30, v18, v14
  v_and_b32 v31, v19, v14
  s_waitcnt vmcnt(5)
  s_cbranch_vccz L_w105
  s_waitcnt vmcnt(4)
L_w105:
  s_addk_i32 s7, -4096
  buffer_load_dwordx4 v[192:195], v2, s[44:47], s7 offen nt
  ds_add_rtn_u32 v90, v88, v89 offset:2844
  v_mfma_f32_16x16x32_bf16 v[24:27], v[28:31], v[248:251], v[24:27]
  v_perm_b32 v14, v56, v56, s12
  v_and_b32 v32, v16, v14
  v_and_b32 v33, v17, v14
  v_and_b32 v34, v18, v14
  v_and_b32 v35, v19, v14
  s_nop 1
  v_mfma_f32_16x16x32_bf16 v[24:27], v[32:35], v[92:95], v[24:27]
  v_perm_b32 v14, v57, v57, s11
  v_and_b32 v28, v16, v14
  v_and_b32 v29, v17, v14
  v_and_b32 v30, v18, v14
  v_and_b32 v31, v19, v14
  s_waitcnt vmcnt(5)
  s_waitcnt lgkmcnt(0)
  v_readfirstlane_b32 s27, v90
  s_nop 0
  s_lshr_b64 vcc, s[26:27], 63
  s_cbranch_vccz L_w106
  s_waitcnt vmcnt(4)
L_w106:
  s_addk_i32 s7, 8192
  buffer_load_dwordx4 v[196:199], v2, s[44:47], s7 offen nt
  v_mfma_f32_16x16x32_bf16 v[24:27], v[28:31], v[96:99], v[24:27]
  v_perm_b32 v14, v57, v57, s12
  v_and_b32 v32, v16, v14
  v_and_b32 v33, v17, v14
  v_and_b32 v34, v18, v14
  v_and_b32 v35, v19, v14
  s_nop 1
  v_mfma_f32_16x16x32_bf16 v[24:27], v[32:35], v[132:135], v[24:27]
  v_perm_b32 v14, v58, v58, s11
  v_and_b32 v28, v16, v14
  v_and_b32 v29, v17, v14
  v_and_b32 v30, v18, v14
  v_and_b32 v31, v19, v14
  s_waitcnt vmcnt(5)
  s_cbranch_vccz L_w107
  s_waitcnt vmcnt(4)
L_w107:
  s_addk_i32 s7, 4096
  buffer_load_dwordx4 v[200:203], v2, s[44:47], s7 offen nt
  ds_add_rtn_u32 v90, v88, v89 offset:2844
  v_mfma_f32_16x16x32_bf16 v[24:27], v[28:31], v[100:103], v[24:27]
  v_perm_b32 v14, v58, v58, s12
  v_and_b32 v32, v16, v14
  v_and_b32 v33, v17, v14
  v_and_b32 v34, v18, v14
  v_and_b32 v35, v19, v14
  s_nop 1
  v_mfma_f32_16x16x32_bf16 v[24:27], v[32:35], v[104:107], v[24:27]
  v_perm_b32 v14, v59, v59, s11
  v_and_b32 v28, v16, v14
  v_and_b32 v29, v17, v14
  v_and_b32 v30, v18, v14
  v_and_b32 v31, v19, v14
  s_waitcnt vmcnt(5)
  s_waitcnt lgkmcnt(0)
  v_readfirstlane_b32 s27, v90
  s_nop 0
  s_lshr_b64 vcc, s[26:27], 63
  s_cbranch_vccz L_w108
  s_waitcnt vmcnt(4)
L_w108:
  s_addk_i32 s7, 8192
  buffer_load_dwordx4 v[204:207], v2, s[44:47], s7 offen nt
  v_mfma_f32_16x16x32_bf16 v[24:27], v[28:31], v[136:139], v[24:27]
  v_perm_b32 v14, v59, v59, s12
  v_and_b32 v32, v16, v14
  v_and_b32 v33, v17, v14
  v_and_b32 v34, v18, v14
  v_and_b32 v35, v19, v14
  s_nop 1
  v_mfma_f32_16x16x32_bf16 v[24:27], v[32:35], v[108:111], v[24:27]
  v_perm_b32 v14, v60, v60, s11
  v_and_b32 v28, v16, v14
  v_and_b32 v29, v17, v14
  v_and_b32 v30, v18, v14
  v_and_b32 v31, v19, v14
  s_waitcnt vmcnt(5)
  s_cbranch_vccz L_w109
  s_waitcnt vmcnt(4)
L_w109:
  s_addk_i32 s7, -4096
  buffer_load_dwordx4 v[208:211], v2, s[44:47], s7 offen nt
  ds_add_rtn_u32 v90, v88, v89 offset:2844
  v_mfma_f32_16x16x32_bf16 v[24:27], v[28:31], v[112:115], v[24:27]
  v_perm_b32 v14, v60, v60, s12
  v_and_b32 v32, v16, v14
  v_and_b32 v33, v17, v14
  v_and_b32 v34, v18, v14
  v_and_b32 v35, v19, v14
  s_nop 1
  v_mfma_f32_16x16x32_bf16 v[24:27], v[32:35], v[140:143], v[24:27]
  v_perm_b32 v14, v61, v61, s11
  v_and_b32 v28, v16, v14
  v_and_b32 v29, v17, v14
  v_and_b32 v30, v18, v14
  v_and_b32 v31, v19, v14
  s_waitcnt vmcnt(5)
  s_waitcnt lgkmcnt(0)
  v_readfirstlane_b32 s27, v90
  s_nop 0
  s_lshr_b64 vcc, s[26:27], 63
  s_cbranch_vccz L_w110
  s_waitcnt vmcnt(4)
L_w110:
  s_addk_i32 s7, 8192
  buffer_load_dwordx4 v[212:215], v2, s[44:47], s7 offen nt
  v_mfma_f32_16x16x32_bf16 v[24:27], v[28:31], v[116:119], v[24:27]
  v_perm_b32 v14, v61, v61, s12
  v_and_b32 v32, v16, v14
  v_and_b32 v33, v17, v14
  v_and_b32 v34, v18, v14
  v_and_b32 v35, v19, v14
  s_nop 1
  v_mfma_f32_16x16x32_bf16 v[24:27], v[32:35], v[120:123], v[24:27]
  v_perm_b32 v14, v62, v62, s11
  v_and_b32 v28, v16, v14
  v_and_b32 v29, v17, v14
  v_and_b32 v30, v18, v14
  v_and_b32 v31, v19, v14
  s_waitcnt vmcnt(5)
  s_cbranch_vccz L_w111
  s_waitcnt vmcnt(4)
L_w111:
  s_addk_i32 s7, 4096
  buffer_load_dwordx4 v[216:219], v2, s[44:47], s7 offen nt
  ds_add_rtn_u32 v90, v88, v89 offset:2844
  v_mfma_f32_16x16x32_bf16 v[24:27], v[28:31], v[144:147], v[24:27]
  v_perm_b32 v14, v62, v62, s12
  v_and_b32 v32, v16, v14
  v_and_b32 v33, v17, v14
  v_and_b32 v34, v18, v14
  v_and_b32 v35, v19, v14
  s_nop 1
  v_mfma_f32_16x16x32_bf16 v[24:27], v[32:35], v[124:127], v[24:27]
  v_perm_b32 v14, v63, v63, s11
  v_and_b32 v28, v16, v14
  v_and_b32 v29, v17, v14
  v_and_b32 v30, v18, v14
  v_and_b32 v31, v19, v14
  s_waitcnt vmcnt(5)
  s_waitcnt lgkmcnt(0)
  v_readfirstlane_b32 s27, v90
  s_nop 0
  s_lshr_b64 vcc, s[26:27], 63
  s_cbranch_vccz L_w112
  s_waitcnt vmcnt(4)
L_w112:
  s_addk_i32 s7, 8192
  buffer_load_dwordx4 v[220:223], v2, s[44:47], s7 offen nt
  v_mfma_f32_16x16x32_bf16 v[24:27], v[28:31], v[128:131], v[24:27]
  v_perm_b32 v14, v63, v63, s12
  v_and_b32 v32, v16, v14
  v_and_b32 v33, v17, v14
  v_and_b32 v34, v18, v14
  v_and_b32 v35, v19, v14
  s_nop 1
  v_mfma_f32_16x16x32_bf16 v[24:27], v[32:35], v[148:151], v[24:27]
  v_perm_b32 v14, v64, v64, s11
  v_and_b32 v28, v16, v14
  v_and_b32 v29, v17, v14
  v_and_b32 v30, v18, v14
  v_and_b32 v31, v19, v14
  s_waitcnt vmcnt(5)
  s_cbranch_vccz L_w113
  s_waitcnt vmcnt(4)
L_w113:
  s_addk_i32 s7, -4096
  buffer_load_dwordx4 v[224:227], v2, s[44:47], s7 offen nt
  ds_add_rtn_u32 v90, v88, v89 offset:2844
  v_mfma_f32_16x16x32_bf16 v[24:27], v[28:31], v[152:155], v[24:27]
  v_perm_b32 v14, v64, v64, s12
  v_and_b32 v32, v16, v14
  v_and_b32 v33, v17, v14
  v_and_b32 v34, v18, v14
  v_and_b32 v35, v19, v14
  s_nop 1
  v_mfma_f32_16x16x32_bf16 v[24:27], v[32:35], v[156:159], v[24:27]
  v_perm_b32 v14, v65, v65, s11
  v_and_b32 v28, v16, v14
  v_and_b32 v29, v17, v14
  v_and_b32 v30, v18, v14
  v_and_b32 v31, v19, v14
  s_waitcnt vmcnt(5)
  s_waitcnt lgkmcnt(0)
  v_readfirstlane_b32 s27, v90
  s_nop 0
  s_lshr_b64 vcc, s[26:27], 63
  s_cbranch_vccz L_w114
  s_waitcnt vmcnt(4)
L_w114:
  s_addk_i32 s7, 8192
  buffer_load_dwordx4 v[228:231], v2, s[44:47], s7 offen nt
  v_mfma_f32_16x16x32_bf16 v[24:27], v[28:31], v[160:163], v[24:27]
  v_perm_b32 v14, v65, v65, s12
  v_and_b32 v32, v16, v14
  v_and_b32 v33, v17, v14
  v_and_b32 v34, v18, v14
  v_and_b32 v35, v19, v14
  s_nop 1
  v_mfma_f32_16x16x32_bf16 v[24:27], v[32:35], v[164:167], v[24:27]
  v_perm_b32 v14, v66, v66, s11
  v_and_b32 v28, v16, v14
  v_and_b32 v29, v17, v14
  v_and_b32 v30, v18, v14
  v_and_b32 v31, v19, v14
  s_waitcnt vmcnt(5)
  s_cbranch_vccz L_w115
  s_waitcnt vmcnt(4)
L_w115:
  s_addk_i32 s7, 4096
  buffer_load_dwordx4 v[232:235], v2, s[44:47], s7 offen nt
  ds_add_rtn_u32 v90, v88, v89 offset:2844
  v_mfma_f32_16x16x32_bf16 v[24:27], v[28:31], v[168:171], v[24:27]
  v_perm_b32 v14, v66, v66, s12
  v_and_b32 v32, v16, v14
  v_and_b32 v33, v17, v14
  v_and_b32 v34, v18, v14
  v_and_b32 v35, v19, v14
  s_nop 1
  v_mfma_f32_16x16x32_bf16 v[24:27], v[32:35], v[172:175], v[24:27]
  v_perm_b32 v14, v67, v67, s11
  v_and_b32 v28, v16, v14
  v_and_b32 v29, v17, v14
  v_and_b32 v30, v18, v14
  v_and_b32 v31, v19, v14
  s_waitcnt vmcnt(5)
  s_waitcnt lgkmcnt(0)
  v_readfirstlane_b32 s27, v90
  s_nop 0
  s_lshr_b64 vcc, s[26:27], 63
  s_cbranch_vccz L_w116
  s_waitcnt vmcnt(4)
L_w116:
  s_addk_i32 s7, 8192
  buffer_load_dwordx4 v[236:239], v2, s[44:47], s7 offen nt
  v_mfma_f32_16x16x32_bf16 v[24:27], v[28:31], v[176:179], v[24:27]
  v_perm_b32 v14, v67, v67, s12
  v_and_b32 v32, v16, v14
  v_and_b32 v33, v17, v14
  v_and_b32 v34, v18, v14
  v_and_b32 v35, v19, v14
  s_nop 1
  v_mfma_f32_16x16x32_bf16 v[24:27], v[32:35], v[180:183], v[24:27]
  v_perm_b32 v14, v68, v68, s11
  v_and_b32 v28, v16, v14
  v_and_b32 v29, v17, v14
  v_and_b32 v30, v18, v14
  v_and_b32 v31, v19, v14
  s_waitcnt vmcnt(5)
  s_cbranch_vccz L_w117
  s_waitcnt vmcnt(4)
L_w117:
  s_addk_i32 s7, -4096
  buffer_load_dwordx4 v[240:243], v2, s[44:47], s7 offen nt
  ds_add_rtn_u32 v90, v88, v89 offset:2844
  v_mfma_f32_16x16x32_bf16 v[24:27], v[28:31], v[184:187], v[24:27]
  v_perm_b32 v14, v68, v68, s12
  v_and_b32 v32, v16, v14
  v_and_b32 v33, v17, v14
  v_and_b32 v34, v18, v14
  v_and_b32 v35, v19, v14
  s_nop 1
  v_mfma_f32_16x16x32_bf16 v[24:27], v[32:35], v[188:191], v[24:27]
  v_perm_b32 v14, v69, v69, s11
  v_and_b32 v28, v16, v14
  v_and_b32 v29, v17, v14
  v_and_b32 v30, v18, v14
  v_and_b32 v31, v19, v14
  s_waitcnt vmcnt(5)
  s_waitcnt lgkmcnt(0)
  v_readfirstlane_b32 s27, v90
  s_nop 0
  s_lshr_b64 vcc, s[26:27], 63
  s_cbranch_vccz L_w118
  s_waitcnt vmcnt(4)
L_w118:
  s_addk_i32 s7, 8192
  buffer_load_dwordx4 v[244:247], v2, s[44:47], s7 offen nt
  v_mfma_f32_16x16x32_bf16 v[24:27], v[28:31], v[192:195], v[24:27]
  v_perm_b32 v14, v69, v69, s12
  v_and_b32 v32, v16, v14
  v_and_b32 v33, v17, v14
  v_and_b32 v34, v18, v14
  v_and_b32 v35, v19, v14
  s_nop 1
  v_mfma_f32_16x16x32_bf16 v[24:27], v[32:35], v[196:199], v[24:27]
  v_perm_b32 v14, v70, v70, s11
  v_and_b32 v28, v16, v14
  v_and_b32 v29, v17, v14
  v_and_b32 v30, v18, v14
  v_and_b32 v31, v19, v14
  s_waitcnt vmcnt(5)
  s_cbranch_vccz L_w119
  s_waitcnt vmcnt(4)
L_w119:
  s_addk_i32 s7, 4096
  buffer_load_dwordx4 v[248:251], v2, s[44:47], s7 offen nt
  ds_add_rtn_u32 v90, v88, v89 offset:2844
  v_mfma_f32_16x16x32_bf16 v[24:27], v[28:31], v[200:203], v[24:27]
  v_perm_b32 v14, v70, v70, s12
  v_and_b32 v32, v16, v14
  v_and_b32 v33, v17, v14
  v_and_b32 v34, v18, v14
  v_and_b32 v35, v19, v14
  s_nop 1
  v_mfma_f32_16x16x32_bf16 v[24:27], v[32:35], v[204:207], v[24:27]
  v_perm_b32 v14, v71, v71, s11
  v_and_b32 v28, v16, v14
  v_and_b32 v29, v17, v14
  v_and_b32 v30, v18, v14
  v_and_b32 v31, v19, v14
  s_waitcnt vmcnt(5)
  s_waitcnt lgkmcnt(0)
  v_readfirstlane_b32 s27, v90
  s_nop 0
  s_lshr_b64 vcc, s[26:27], 63
  s_cbranch_vccz L_w120
  s_waitcnt vmcnt(4)
L_w120:
  s_addk_i32 s7, 8192
  buffer_load_dwordx4 v[92:95], v2, s[44:47], s7 offen nt
  v_mfma_f32_16x16x32_bf16 v[24:27], v[28:31], v[208:211], v[24:27]
  v_perm_b32 v14, v71, v71, s12
  v_and_b32 v32, v16, v14
  v_and_b32 v33, v17, v14
  v_and_b32 v34, v18, v14
  v_and_b32 v35, v19, v14
  s_nop 1
  v_mfma_f32_16x16x32_bf16 v[24:27], v[32:35], v[212:215], v[24:27]
  v_perm_b32 v14, v72, v72, s11
  v_and_b32 v28, v16, v14
  v_and_b32 v29, v17, v14
  v_and_b32 v30, v18, v14
  v_and_b32 v31, v19, v14
  s_waitcnt vmcnt(5)
  s_cbranch_vccz L_w121
  s_waitcnt vmcnt(4)
L_w121:
  s_addk_i32 s7, -4096
  buffer_load_dwordx4 v[96:99], v2, s[44:47], s7 offen nt
  ds_add_rtn_u32 v90, v88, v89 offset:2844
  v_mfma_f32_16x16x32_bf16 v[24:27], v[28:31], v[216:219], v[24:27]
  v_perm_b32 v14, v72, v72, s12
  v_and_b32 v32, v16, v14
  v_and_b32 v33, v17, v14
  v_and_b32 v34, v18, v14
  v_and_b32 v35, v19, v14
  s_nop 1
  v_mfma_f32_16x16x32_bf16 v[24:27], v[32:35], v[220:223], v[24:27]
  v_perm_b32 v14, v73, v73, s11
  v_and_b32 v28, v16, v14
  v_and_b32 v29, v17, v14
  v_and_b32 v30, v18, v14
  v_and_b32 v31, v19, v14
  s_waitcnt vmcnt(5)
  s_waitcnt lgkmcnt(0)
  v_readfirstlane_b32 s27, v90
  s_nop 0
  s_lshr_b64 vcc, s[26:27], 63
  s_cbranch_vccz L_w122
  s_waitcnt vmcnt(4)
L_w122:
  s_addk_i32 s7, 8192
  buffer_load_dwordx4 v[132:135], v2, s[44:47], s7 offen nt
  v_mfma_f32_16x16x32_bf16 v[24:27], v[28:31], v[224:227], v[24:27]
  v_perm_b32 v14, v73, v73, s12
  v_and_b32 v32, v16, v14
  v_and_b32 v33, v17, v14
  v_and_b32 v34, v18, v14
  v_and_b32 v35, v19, v14
  s_nop 1
  v_mfma_f32_16x16x32_bf16 v[24:27], v[32:35], v[228:231], v[24:27]
  v_perm_b32 v14, v74, v74, s11
  v_and_b32 v28, v16, v14
  v_and_b32 v29, v17, v14
  v_and_b32 v30, v18, v14
  v_and_b32 v31, v19, v14
  s_waitcnt vmcnt(5)
  s_cbranch_vccz L_w123
  s_waitcnt vmcnt(4)
L_w123:
  s_addk_i32 s7, 4096
  buffer_load_dwordx4 v[100:103], v2, s[44:47], s7 offen nt
  ds_add_rtn_u32 v90, v88, v89 offset:2844
  v_mfma_f32_16x16x32_bf16 v[24:27], v[28:31], v[232:235], v[24:27]
  v_perm_b32 v14, v74, v74, s12
  v_and_b32 v32, v16, v14
  v_and_b32 v33, v17, v14
  v_and_b32 v34, v18, v14
  v_and_b32 v35, v19, v14
  s_nop 1
  v_mfma_f32_16x16x32_bf16 v[24:27], v[32:35], v[236:239], v[24:27]
  v_perm_b32 v14, v75, v75, s11
  v_and_b32 v28, v16, v14
  v_and_b32 v29, v17, v14
  v_and_b32 v30, v18, v14
  v_and_b32 v31, v19, v14
  s_waitcnt vmcnt(5)
  s_waitcnt lgkmcnt(0)
  v_readfirstlane_b32 s27, v90
  s_nop 0
  s_lshr_b64 vcc, s[26:27], 63
  s_cbranch_vccz L_w124
  s_waitcnt vmcnt(4)
L_w124:
  s_addk_i32 s7, 8192
  buffer_load_dwordx4 v[104:107], v2, s[44:47], s7 offen nt
  v_mfma_f32_16x16x32_bf16 v[24:27], v[28:31], v[240:243], v[24:27]
  v_perm_b32 v14, v75, v75, s12
  v_and_b32 v32, v16, v14
  v_and_b32 v33, v17, v14
  v_and_b32 v34, v18, v14
  v_and_b32 v35, v19, v14
  s_nop 1
  v_mfma_f32_16x16x32_bf16 v[24:27], v[32:35], v[244:247], v[24:27]
  v_perm_b32 v14, v76, v76, s11
  v_and_b32 v28, v16, v14
  v_and_b32 v29, v17, v14
  v_and_b32 v30, v18, v14
  v_and_b32 v31, v19, v14
  s_waitcnt vmcnt(5)
  s_cbranch_vccz L_w125
  s_waitcnt vmcnt(4)
L_w125:
  s_addk_i32 s7, -4096
  buffer_load_dwordx4 v[136:139], v2, s[44:47], s7 offen nt
  ds_add_rtn_u32 v90, v88, v89 offset:2844
  v_mfma_f32_16x16x32_bf16 v[24:27], v[28:31], v[248:251], v[24:27]
  v_perm_b32 v14, v76, v76, s12
  v_and_b32 v32, v16, v14
  v_and_b32 v33, v17, v14
  v_and_b32 v34, v18, v14
  v_and_b32 v35, v19, v14
  s_waitcnt vmcnt(5)
  s_waitcnt lgkmcnt(0)
  v_readfirstlane_b32 s27, v90
  s_nop 0
  s_lshr_b64 vcc, s[26:27], 63
  s_cbranch_vccz L_w126
  s_waitcnt vmcnt(4)
L_w126:
  s_addk_i32 s7, 8192
  buffer_load_dwordx4 v[108:111], v2, s[44:47], s7 offen nt
  v_mfma_f32_16x16x32_bf16 v[24:27], v[32:35], v[92:95], v[24:27]
  v_perm_b32 v14, v77, v77, s11
  v_and_b32 v28, v16, v14
  v_and_b32 v29, v17, v14
  v_and_b32 v30, v18, v14
  v_and_b32 v31, v19, v14
  s_waitcnt vmcnt(5)
  s_cbranch_vccz L_w127
  s_waitcnt vmcnt(4)
L_w127:
  s_addk_i32 s7, 4096
  buffer_load_dwordx4 v[112:115], v2, s[44:47], s7 offen nt
  ds_add_rtn_u32 v90, v88, v89 offset:2844
  v_mfma_f32_16x16x32_bf16 v[24:27], v[28:31], v[96:99], v[24:27]
  v_perm_b32 v14, v77, v77, s12
  v_and_b32 v32, v16, v14
  v_and_b32 v33, v17, v14
  v_and_b32 v34, v18, v14
  v_and_b32 v35, v19, v14
  s_waitcnt vmcnt(5)
  s_waitcnt lgkmcnt(0)
  v_readfirstlane_b32 s27, v90
  s_nop 0
  s_lshr_b64 vcc, s[26:27], 63
  s_cbranch_vccz L_w128
  s_waitcnt vmcnt(4)
L_w128:
  s_addk_i32 s7, 8192
  buffer_load_dwordx4 v[140:143], v2, s[44:47], s7 offen nt
  v_mfma_f32_16x16x32_bf16 v[24:27], v[32:35], v[132:135], v[24:27]
  v_perm_b32 v14, v78, v78, s11
  v_and_b32 v28, v16, v14
  v_and_b32 v29, v17, v14
  v_and_b32 v30, v18, v14
  v_and_b32 v31, v19, v14
  s_waitcnt vmcnt(5)
  s_cbranch_vccz L_w129
  s_waitcnt vmcnt(4)
L_w129:
  s_addk_i32 s7, -4096
  buffer_load_dwordx4 v[116:119], v2, s[44:47], s7 offen nt
  ds_add_rtn_u32 v90, v88, v89 offset:2844
  v_mfma_f32_16x16x32_bf16 v[24:27], v[28:31], v[100:103], v[24:27]
  v_perm_b32 v14, v78, v78, s12
  v_and_b32 v32, v16, v14
  v_and_b32 v33, v17, v14
  v_and_b32 v34, v18, v14
  v_and_b32 v35, v19, v14
  s_waitcnt vmcnt(5)
  s_waitcnt lgkmcnt(0)
  v_readfirstlane_b32 s27, v90
  s_nop 0
  s_lshr_b64 vcc, s[26:27], 63
  s_cbranch_vccz L_w130
  s_waitcnt vmcnt(4)
L_w130:
  s_addk_i32 s7, 8192
  buffer_load_dwordx4 v[120:123], v2, s[44:47], s7 offen nt
  v_mfma_f32_16x16x32_bf16 v[24:27], v[32:35], v[104:107], v[24:27]
  v_perm_b32 v14, v79, v79, s11
  v_and_b32 v28, v16, v14
  v_and_b32 v29, v17, v14
  v_and_b32 v30, v18, v14
  v_and_b32 v31, v19, v14
  s_waitcnt vmcnt(5)
  s_cbranch_vccz L_w131
  s_waitcnt vmcnt(4)
L_w131:
  s_addk_i32 s7, 4096
  buffer_load_dwordx4 v[144:147], v2, s[44:47], s7 offen nt
  ds_add_rtn_u32 v90, v88, v89 offset:2844
  v_mfma_f32_16x16x32_bf16 v[24:27], v[28:31], v[136:139], v[24:27]
  v_perm_b32 v14, v79, v79, s12
  v_and_b32 v32, v16, v14
  v_and_b32 v33, v17, v14
  v_and_b32 v34, v18, v14
  v_and_b32 v35, v19, v14
  s_waitcnt vmcnt(5)
  s_waitcnt lgkmcnt(0)
  v_readfirstlane_b32 s27, v90
  s_nop 0
  s_lshr_b64 vcc, s[26:27], 63
  s_cbranch_vccz L_w132
  s_waitcnt vmcnt(4)
L_w132:
  s_addk_i32 s7, 8192
  buffer_load_dwordx4 v[124:127], v2, s[44:47], s7 offen nt
  v_mfma_f32_16x16x32_bf16 v[24:27], v[32:35], v[108:111], v[24:27]
  v_perm_b32 v14, v80, v80, s11
  v_and_b32 v28, v16, v14
  v_and_b32 v29, v17, v14
  v_and_b32 v30, v18, v14
  v_and_b32 v31, v19, v14
  s_waitcnt vmcnt(5)
  s_cbranch_vccz L_w133
  s_waitcnt vmcnt(4)
L_w133:
  s_addk_i32 s7, -4096
  buffer_load_dwordx4 v[128:131], v2, s[44:47], s7 offen nt
  ds_add_rtn_u32 v90, v88, v89 offset:2844
  v_mfma_f32_16x16x32_bf16 v[24:27], v[28:31], v[112:115], v[24:27]
  v_perm_b32 v14, v80, v80, s12
  v_and_b32 v32, v16, v14
  v_and_b32 v33, v17, v14
  v_and_b32 v34, v18, v14
  v_and_b32 v35, v19, v14
  s_mov_b64 exec, 1
  ds_add_u32 v7, v89 offset:2836
  s_mov_b64 exec, -1
  s_waitcnt lgkmcnt(0)
  v_readfirstlane_b32 s27, v90
  s_nop 0
  s_lshr_b64 vcc, s[26:27], 63
  s_cbranch_vccz L_w134
  s_waitcnt vmcnt(4)
L_w134:
  s_addk_i32 s7, 8192
  buffer_load_dwordx4 v[148:151], v2, s[44:47], s7 offen nt
  s_waitcnt vmcnt(6)
  s_addk_i32 s7, 4096
  buffer_load_dwordx4 v[152:155], v2, s[44:47], s7 offen nt
  v_mfma_f32_16x16x32_bf16 v[24:27], v[32:35], v[140:143], v[24:27]
  v_perm_b32 v14, v81, v81, s11
  v_and_b32 v28, v16, v14
  v_and_b32 v29, v17, v14
  v_and_b32 v30, v18, v14
  v_and_b32 v31, v19, v14
  s_addk_i32 s7, 8192
  buffer_load_dwordx4 v[156:159], v2, s[44:47], s7 offen nt
  s_waitcnt vmcnt(7)
  s_addk_i32 s7, -4096
  buffer_load_dwordx4 v[160:163], v2, s[44:47], s7 offen nt
  v_mfma_f32_16x16x32_bf16 v[24:27], v[28:31], v[116:119], v[24:27]
  v_perm_b32 v14, v81, v81, s12
  v_and_b32 v32, v16, v14
  v_and_b32 v33, v17, v14
  v_and_b32 v34, v18, v14
  v_and_b32 v35, v19, v14
  s_waitcnt vmcnt(7)
  s_addk_i32 s7, 8192
  buffer_load_dwordx4 v[164:167], v2, s[44:47], s7 offen nt
  v_mfma_f32_16x16x32_bf16 v[24:27], v[32:35], v[120:123], v[24:27]
  v_perm_b32 v14, v82, v82, s11
  v_and_b32 v28, v16, v14
  v_and_b32 v29, v17, v14
  v_and_b32 v30, v18, v14
  v_and_b32 v31, v19, v14
  s_addk_i32 s7, 4096
  buffer_load_dwordx4 v[168:171], v2, s[44:47], s7 offen nt
  s_waitcnt vmcnt(8)
  s_addk_i32 s7, 8192
  buffer_load_dwordx4 v[172:175], v2, s[44:47], s7 offen nt
  v_mfma_f32_16x16x32_bf16 v[24:27], v[28:31], v[144:147], v[24:27]
  v_perm_b32 v14, v82, v82, s12
  v_and_b32 v32, v16, v14
  v_and_b32 v33, v17, v14
  v_and_b32 v34, v18, v14
  v_and_b32 v35, v19, v14
  s_waitcnt vmcnt(8)
  s_addk_i32 s7, -4096
  buffer_load_dwordx4 v[176:179], v2, s[44:47], s7 offen nt
  v_mfma_f32_16x16x32_bf16 v[24:27], v[32:35], v[124:127], v[24:27]
  v_perm_b32 v14, v83, v83, s11
  v_and_b32 v28, v16, v14
  v_and_b32 v29, v17, v14
  v_and_b32 v30, v18, v14
  v_and_b32 v31, v19, v14
  s_addk_i32 s7, 8192
  buffer_load_dwordx4 v[180:183], v2, s[44:47], s7 offen nt
  s_waitcnt vmcnt(9)
  buffer_load_dwordx4 v[184:187], v4, s[56:59], s98 offen offset:0 nt
  buffer_load_dwordx4 v[188:191], v4, s[56:59], s101 offen offset:1024 nt
  s_add_u32 s14, s101, 9216
  buffer_load_dwordx4 v[192:195], v4, s[56:59], s14 offen offset:1024 nt
  s_add_u32 s14, s98, 18432
  buffer_load_dwordx4 v[196:199], v5, s[56:59], s14 offen offset:0 nt
  v_mfma_f32_16x16x32_bf16 v[24:27], v[28:31], v[128:131], v[24:27]
  v_perm_b32 v14, v83, v83, s12
  v_and_b32 v32, v16, v14
  v_and_b32 v33, v17, v14
  v_and_b32 v34, v18, v14
  v_and_b32 v35, v19, v14
  s_waitcnt vmcnt(12)
  buffer_load_dwordx4 v[200:203], v4, s[56:59], s98 offen offset:512 nt
  s_add_u32 s14, s98, 18432
  buffer_load_dwordx4 v[204:207], v5, s[56:59], s14 offen offset:512 nt
  s_add_u32 s14, s101, 18432
  buffer_load_dwordx4 v[208:211], v5, s[56:59], s14 offen offset:1024 nt
  v_mfma_f32_16x16x32_bf16 v[24:27], v[32:35], v[148:151], v[24:27]
  v_perm_b32 v14, v84, v84, s11
  v_and_b32 v28, v16, v14
  v_and_b32 v29, v17, v14
  v_and_b32 v30, v18, v14
  v_and_b32 v31, v19, v14
  s_waitcnt vmcnt(14)
  s_add_u32 s14, s98, 9216
  buffer_load_dwordx4 v[212:215], v4, s[56:59], s14 offen offset:0 nt
  buffer_load_dwordx4 v[216:219], v3, s[52:55], s100 offen offset:1024 nt
  s_add_u32 s14, s100, 18432
  buffer_load_dwordx4 v[220:223], v3, s[52:55], s14 offen offset:1024 nt
  v_mfma_f32_16x16x32_bf16 v[24:27], v[28:31], v[152:155], v[24:27]
  v_perm_b32 v14, v84, v84, s12
  v_and_b32 v32, v16, v14
  v_and_b32 v33, v17, v14
  v_and_b32 v34, v18, v14
  v_and_b32 v35, v19, v14
  s_waitcnt vmcnt(16)
  s_nop 0
  v_mfma_f32_16x16x32_bf16 v[24:27], v[32:35], v[156:159], v[24:27]
  v_perm_b32 v14, v85, v85, s11
  v_and_b32 v28, v16, v14
  v_and_b32 v29, v17, v14
  v_and_b32 v30, v18, v14
  v_and_b32 v31, v19, v14
  ds_read_b32 v91, v7 offset:2828
  ds_read_b32 v52, v39 offset:3328
  ds_read_b32 v53, v39 offset:3360
  ds_read_b32 v54, v39 offset:3392
  s_waitcnt vmcnt(15)
  v_mfma_f32_16x16x32_bf16 v[24:27], v[28:31], v[160:163], v[24:27]
  v_perm_b32 v14, v85, v85, s12
  v_and_b32 v32, v16, v14
  v_and_b32 v33, v17, v14
  v_and_b32 v34, v18, v14
  v_and_b32 v35, v19, v14
  s_waitcnt lgkmcnt(0)
  v_readfirstlane_b32 s27, v91
  s_nop 0
  s_cmp_lt_u32 s27, 1
  s_cbranch_scc1 L_hw
L_hw_ok:
  v_and_b32 v40, v16, v52
  v_and_b32 v41, v17, v52
  v_and_b32 v42, v18, v52
  v_and_b32 v43, v19, v52
  s_waitcnt vmcnt(14)
  v_mfma_f32_16x16x32_bf16 v[24:27], v[32:35], v[164:167], v[24:27]
  v_perm_b32 v14, v86, v86, s11
  v_and_b32 v28, v16, v14
  v_and_b32 v29, v17, v14
  v_and_b32 v30, v18, v14
  v_and_b32 v31, v19, v14
  v_and_b32 v44, v16, v53
  v_and_b32 v45, v17, v53
  v_and_b32 v46, v18, v53
  v_and_b32 v47, v19, v53
  s_waitcnt vmcnt(13)
  v_mfma_f32_16x16x32_bf16 v[24:27], v[28:31], v[168:171], v[24:27]
  v_perm_b32 v14, v86, v86, s12
  v_and_b32 v32, v16, v14
  v_and_b32 v33, v17, v14
  v_and_b32 v34, v18, v14
  v_and_b32 v35, v19, v14
  v_and_b32 v48, v16, v54
  v_and_b32 v49, v17, v54
  v_and_b32 v50, v18, v54
  v_and_b32 v51, v19, v54
  s_waitcnt vmcnt(12)
  v_mfma_f32_16x16x32_bf16 v[24:27], v[32:35], v[172:175], v[24:27]
  v_perm_b32 v14, v87, v87, s11
  v_and_b32 v28, v16, v14
  v_and_b32 v29, v17, v14
  v_and_b32 v30, v18, v14
  v_and_b32 v31, v19, v14
  s_waitcnt vmcnt(11)
  s_nop 0
  v_mfma_f32_16x16x32_bf16 v[24:27], v[28:31], v[176:179], v[24:27]
  v_perm_b32 v14, v87, v87, s12
  v_and_b32 v32, v16, v14
  v_and_b32 v33, v17, v14
  v_and_b32 v34, v18, v14
  v_and_b32 v35, v19, v14
  s_waitcnt vmcnt(10)
  s_nop 0
  v_mfma_f32_16x16x32_bf16 v[24:27], v[32:35], v[180:183], v[24:27]
  s_nop 7
  ds_write_b128 v10, v[24:27] offset:4096
  s_mov_b64 exec, 1
  ds_add_u32 v7, v89 offset:2816
  s_mov_b64 exec, -1
  s_mul_i32 s14, s5, 20480
  s_lshl_b32 s15, s6, 6
  s_add_u32 s14, s14, s15
  s_add_u32 s14, s14, 131072
  s_mov_b32 s51, s14
  s_mov_b32 s96, 0
  s_barrier
  buffer_load_dwordx4 v[68:71], v36, s[60:63], s51 offen sc1
  s_add_u32 s14, s98, 9216
  buffer_load_dwordx4 v[224:227], v4, s[56:59], s14 offen offset:512 nt
  buffer_load_dwordx4 v[228:231], v3, s[52:55], s97 offen offset:0 nt
  s_add_u32 s14, s97, 18432
  buffer_load_dwordx4 v[232:235], v3, s[52:55], s14 offen offset:0 nt
  buffer_load_dwordx4 v[236:239], v3, s[52:55], s97 offen offset:512 nt
  s_add_u32 s14, s97, 18432
  buffer_load_dwordx4 v[240:243], v3, s[52:55], s14 offen offset:512 nt
  s_waitcnt vmcnt(15)
  v_mfma_f32_16x16x32_bf16 v[56:59], v[40:43], v[184:187], 0
  s_waitcnt vmcnt(14)
  v_mfma_f32_16x16x32_bf16 v[64:67], v[40:43], v[188:191], 0
  s_waitcnt vmcnt(13)
  v_mfma_f32_16x16x32_bf16 v[64:67], v[44:47], v[192:195], v[64:67]
  s_waitcnt vmcnt(12)
  v_mfma_f32_16x16x32_bf16 v[56:59], v[48:51], v[196:199], v[56:59]
  s_waitcnt vmcnt(11)
  v_mfma_f32_16x16x32_bf16 v[60:63], v[40:43], v[200:203], 0
  s_waitcnt vmcnt(10)
  v_mfma_f32_16x16x32_bf16 v[60:63], v[48:51], v[204:207], v[60:63]
  s_waitcnt vmcnt(9)
  v_mfma_f32_16x16x32_bf16 v[64:67], v[48:51], v[208:211], v[64:67]
  s_waitcnt vmcnt(8)
  v_mfma_f32_16x16x32_bf16 v[56:59], v[44:47], v[212:215], v[56:59]
  s_waitcnt vmcnt(5)
  s_branch L_chk1
L_poll1:
  buffer_load_dwordx4 v[68:71], v36, s[60:63], s51 offen sc1
  s_add_u32 s96, s96, 1
  s_cmp_gt_u32 s96, 100000
  s_cbranch_scc1 L_1_done
  s_waitcnt vmcnt(0)
L_chk1:
  v_xor_b32 v68, s28, v68
  v_xor_b32 v69, s29, v69
  v_xor_b32 v70, s30, v70
  v_xor_b32 v71, s31, v71
  v_or3_b32 v12, v68, v69, v70
  v_or_b32 v12, v12, v71
  v_cmp_ne_u32_sdwa vcc, v12, 0 src0_sel:BYTE_0 src1_sel:DWORD
  s_nop 0
  s_and_b64 exec, exec, vcc
  s_cbranch_scc1 L_poll1
L_1_done:
  s_mov_b64 exec, -1
  v_permlane32_swap_b32 v68, v70
  v_permlane32_swap_b32 v69, v71
  v_add_f32 v68, v68, v70
  v_add_f32 v69, v69, v71
  s_nop 1
  v_permlane16_swap_b32 v68, v69
  v_add_f32 v68, v68, v69
  s_nop 1
  v_add_f32_dpp v68, v68, v68 row_ror:4 row_mask:0xf bank_mask:0xf
  s_nop 1
  v_add_f32_dpp v68, v68, v68 row_ror:8 row_mask:0xf bank_mask:0xf
  v_cvt_pk_bf16_f32 v70, v68, v68
  s_nop 1
  v_mov_b32_dpp v68, v70 quad_perm:[0,0,0,0] row_mask:0xf bank_mask:0x3
  v_mov_b32_dpp v69, v70 quad_perm:[2,2,2,2] row_mask:0xf bank_mask:0x3
  s_nop 0
  v_mov_b32_dpp v68, v70 quad_perm:[1,1,1,1] row_mask:0xf bank_mask:0xc
  v_mov_b32_dpp v69, v70 quad_perm:[3,3,3,3] row_mask:0xf bank_mask:0xc
  v_and_b32 v28, v16, v68
  v_and_b32 v29, v17, v68
  v_and_b32 v30, v18, v68
  v_and_b32 v31, v19, v68
  v_and_b32 v32, v16, v69
  v_and_b32 v33, v17, v69
  v_mfma_f32_16x16x32_bf16 v[64:67], v[28:31], v[216:219], v[64:67]
  v_and_b32 v34, v18, v69
  v_and_b32 v35, v19, v69
  s_nop 1
  v_mfma_f32_16x16x32_bf16 v[64:67], v[32:35], v[220:223], v[64:67]
  s_nop 7
  v_permlane32_swap_b32 v64, v20
  v_permlane32_swap_b32 v65, v21
  v_permlane32_swap_b32 v66, v22
  v_permlane32_swap_b32 v67, v23
  v_add_f32_dpp v20, v64, v20 row_ror:8 row_mask:0xf bank_mask:0xc
  v_add_f32_dpp v21, v65, v21 row_ror:8 row_mask:0xf bank_mask:0xc
  v_add_f32_dpp v22, v66, v22 row_ror:8 row_mask:0xf bank_mask:0xc
  v_add_f32_dpp v23, v67, v23 row_ror:8 row_mask:0xf bank_mask:0xc
  s_waitcnt vmcnt(4)
  v_mfma_f32_16x16x32_bf16 v[60:63], v[44:47], v[224:227], v[60:63]
  s_waitcnt vmcnt(3)
  v_mfma_f32_16x16x32_bf16 v[56:59], v[28:31], v[228:231], v[56:59]
  s_waitcnt vmcnt(2)
  v_mfma_f32_16x16x32_bf16 v[56:59], v[32:35], v[232:235], v[56:59]
  s_waitcnt vmcnt(1)
  v_mfma_f32_16x16x32_bf16 v[60:63], v[28:31], v[236:239], v[60:63]
  s_waitcnt vmcnt(0)
  v_mfma_f32_16x16x32_bf16 v[60:63], v[32:35], v[240:243], v[60:63]
  s_nop 7
  v_permlane32_swap_b32 v56, v60
  v_permlane32_swap_b32 v57, v61
  v_permlane32_swap_b32 v58, v62
  v_permlane32_swap_b32 v59, v63
  v_add_f32_dpp v20, v60, v56 row_ror:8 row_mask:0xf bank_mask:0x3
  v_add_f32_dpp v21, v61, v57 row_ror:8 row_mask:0xf bank_mask:0x3
  v_add_f32_dpp v22, v62, v58 row_ror:8 row_mask:0xf bank_mask:0x3
  v_add_f32_dpp v23, v63, v59 row_ror:8 row_mask:0xf bank_mask:0x3
  v_mov_b32_sdwa v20, s49 dst_sel:BYTE_0 dst_unused:UNUSED_PRESERVE src0_sel:BYTE_0
  v_mov_b32_sdwa v21, s49 dst_sel:BYTE_0 dst_unused:UNUSED_PRESERVE src0_sel:BYTE_1
  v_mov_b32_sdwa v22, s49 dst_sel:BYTE_0 dst_unused:UNUSED_PRESERVE src0_sel:BYTE_2
  v_mov_b32_sdwa v23, s49 dst_sel:BYTE_0 dst_unused:UNUSED_PRESERVE src0_sel:BYTE_3
  s_cmp_eq_u32 s99, 0
  s_cbranch_scc1 L_wt3
  buffer_store_dwordx4 v[20:23], v6, s[60:63], s48 offen
L_wb3:
  s_barrier
  s_endpgm
L_xw:
  s_mov_b32 s96, 0
L_xw_l:
  ds_read_b32 v91, v7 offset:2820
  ds_read_b32 v40, v10 offset:0
  ds_read_b32 v41, v10 offset:32
  ds_read_b32 v42, v10 offset:64
  ds_read_b32 v43, v10 offset:96
  ds_read_b32 v44, v10 offset:128
  s_add_u32 s96, s96, 1
  s_waitcnt lgkmcnt(0)
  v_readfirstlane_b32 s27, v91
  s_cmp_gt_u32 s96, 1000000
  s_cbranch_scc1 L_xw_ok
  s_cmp_lt_u32 s27, 1
  s_cbranch_scc1 L_xw_l
  s_branch L_xw_ok
L_qw:
  s_mov_b32 s96, 0
L_qw_l:
  ds_read_b32 v91, v7 offset:2820
  ds_read_b128 v[20:23], v11 offset:2304
  s_add_u32 s96, s96, 1
  s_waitcnt lgkmcnt(0)
  v_readfirstlane_b32 s27, v91
  s_cmp_gt_u32 s96, 1000000
  s_cbranch_scc1 L_qw_ok
  s_cmp_lt_u32 s27, 2
  s_cbranch_scc1 L_qw_l
  s_branch L_qw_ok
L_hw:
  s_mov_b32 s96, 0
L_hw_l:
  ds_read_b32 v91, v7 offset:2828
  ds_read_b32 v52, v39 offset:3328
  ds_read_b32 v53, v39 offset:3360
  ds_read_b32 v54, v39 offset:3392
  s_add_u32 s96, s96, 1
  s_waitcnt lgkmcnt(0)
  v_readfirstlane_b32 s27, v91
  s_cmp_gt_u32 s96, 1000000
  s_cbranch_scc1 L_hw_ok
  s_cmp_lt_u32 s27, 1
  s_cbranch_scc1 L_hw_l
  s_branch L_hw_ok
L_wt3:
  s_nop 1
  buffer_store_dwordx4 v[20:23], v6, s[60:63], s48 offen sc1
  s_branch L_wb3
L_q_wt:
  s_mov_b32 s99, 0
  s_mov_b32 exec_lo, 0xffff0000
  buffer_store_dwordx4 v[58:61], v1, s[60:63], s58 offen sc1
  s_mov_b64 exec, 0x00ff00ff
  buffer_store_dwordx4 v[8:11], v28, s[60:63], s58 offen sc1
  s_mov_b64 exec, 0xff
  buffer_store_dwordx4 v[60:63], v1, s[60:63], s58 offen offset:1024 sc1
  s_mov_b64 exec, -1
  s_branch L_q_test
L_wt5:
  s_nop 1
  buffer_store_dwordx4 v[64:67], v1, s[60:63], s7 offen sc1
  buffer_store_dwordx4 v[68:71], v1, s[60:63], s7 offen offset:1024 sc1
  buffer_store_dwordx4 v[72:75], v28, s[60:63], s7 offen offset:2048 sc1
  s_branch L_wb5
L_wt6:
  s_nop 1
  buffer_store_dwordx4 v[48:51], v28, s[60:63], s58 offen offset:1024 sc1
  s_branch L_wb6
L_wt7:
  s_nop 1
  buffer_store_dwordx4 v[64:67], v1, s[60:63], s58 offen sc1
  s_branch L_wb7
.section .rodata,"a"
.p2align 6
.amdhsa_kernel parallel_sum__gqa_block_cached__swiglu_ffn__decode_kernel
  .amdhsa_next_free_vgpr 256
  .amdhsa_next_free_sgpr 102
  .amdhsa_accum_offset 256
  .amdhsa_group_segment_fixed_size 0
  .amdhsa_kernarg_size 96
  .amdhsa_user_sgpr_count 2
  .amdhsa_user_sgpr_kernarg_segment_ptr 1
  .amdhsa_system_sgpr_workgroup_id_x 1
.end_amdhsa_kernel
```
